```python
import torch

def _softmax(x, axis=-1):
    return torch.softmax(x, dim=axis)
def _gelu(x):
    return torch.nn.functional.gelu(x, approximate="tanh")
def _silu(x):
    return torch.nn.functional.silu(x)
def _sigmoid(x):
    return torch.sigmoid(x)
def _layernorm(x, axis=-1, eps=1e-5):
    m = x.mean(dim=axis, keepdim=True)
    v = x.var(dim=axis, keepdim=True, unbiased=False)
    return (x - m) / torch.sqrt(v + eps)
def _scatter_add(tgt, idx, src, axis=0):
    return tgt.clone().index_add_(axis, idx, src)
def _segment_sum(src, seg, n):
    out = torch.zeros((n,) + src.shape[1:], dtype=src.dtype)
    return out.index_add_(0, seg, src)
def _pad(x, pw):
    flat = tuple(v for pair in reversed(pw) for v in pair)
    return torch.nn.functional.pad(x, flat)

kernel_name = 'recurrent_scan__sliding_block_cached__dense_activation_gelu__decode'

def setup_inputs():

    _w = (lambda a: (lambda t: t.to(torch.bfloat16) if t.is_floating_point() else t)(torch.as_tensor(a)))
    def _A_setup():
        B, Sq, D = 8, 1, 1024
        Hq, Hkv, Sk, Dh = 32, 4, 4096, 128
        assert Hq % Hkv == 0, (Hq, Hkv)
        return {
            "x": _w((lambda *s: torch.randn(*s, dtype=torch.bfloat16) * 0.05)(B, Sq, D)),
            "k_cache": _w((lambda *s: torch.randn(*s, dtype=torch.bfloat16) * 3.2)(B, Hkv, Sk, Dh)),
            "v_cache": _w((lambda *s: torch.randn(*s, dtype=torch.bfloat16) * 3.2)(B, Hkv, Sk, Dh)),
            "wq": _w((lambda *s: torch.randn(*s, dtype=torch.bfloat16) * 3.2)(D, Hq * Dh) * (D ** -0.5)),
            "wo": _w((lambda *s: torch.randn(*s, dtype=torch.bfloat16) * 3.2)(Hq * Dh, D) * ((Hq * Dh) ** -0.5)),
        }
    _A_in = _A_setup()

    def _B_setup():
        B, S, D, F = 8, 1, 1024, 3584
        return {
            "x": _w((lambda *s: torch.randn(*s, dtype=torch.bfloat16) * 0.05)(B, S, D)),
            "w1": _w((lambda *s: torch.randn(*s, dtype=torch.bfloat16) * 3.2)(D, F) * (D ** -0.5)),
            "b1": _w((lambda *s: torch.randn(*s, dtype=torch.bfloat16) * 3.2)(F) * 0.01),
            "w2": _w((lambda *s: torch.randn(*s, dtype=torch.bfloat16) * 0.8)(F, D) * (F ** -0.5)),
            "b2": _w((lambda *s: torch.randn(*s, dtype=torch.bfloat16) * 0.8)(D) * 0.01),
        }
    _B_in = _B_setup()

    return {
        "A_x": _A_in["x"],
        "A_k_cache": _A_in["k_cache"],
        "A_v_cache": _A_in["v_cache"],
        "A_wq": _A_in["wq"],
        "A_wo": _A_in["wo"],
        "B_x": _B_in["x"],
        "B_w1": _B_in["w1"],
        "B_b1": _B_in["b1"],
        "B_w2": _B_in["w2"],
        "B_b2": _B_in["b2"],
    }

def reference(A_x, A_k_cache, A_v_cache, A_wq, A_wo, B_x, B_w1, B_b1, B_w2, B_b2):
    def _A_ref(x, k_cache, v_cache, wq, wo):
        B, Sq, D = x.shape
        Hq, Dh = 32, 128
        Hkv, Sk = k_cache.shape[1], k_cache.shape[2]
        W = min(4096, max(256, Sk // 4))
        rep = Hq // Hkv
        q = (lambda x, *d: x.permute(*d))((x @ wq).reshape(B, Sq, Hq, Dh), 0, 2, 1, 3)
        k = (lambda x, n, axis: torch.repeat_interleave(x, n, dim=axis))(k_cache[:, :, Sk - W:, :], rep, axis=1)
        v = (lambda x, n, axis: torch.repeat_interleave(x, n, dim=axis))(v_cache[:, :, Sk - W:, :], rep, axis=1)
        scores = torch.einsum("bhqd,bhkd->bhqk", q, k) * (Dh ** -0.5)
        p = _softmax(scores, axis=-1)
        o = torch.einsum("bhqk,bhkd->bhqd", p, v)
        return (lambda x, *d: x.permute(*d))(o, 0, 2, 1, 3).reshape(B, Sq, Hq * Dh) @ wo

    def _B_ref(x, w1, b1, w2, b2):
        h = torch.einsum("bsd,df->bsf", x, w1) + b1
        h = _gelu(h)
        return torch.einsum("bsf,fd->bsd", h, w2) + b2

    x = A_x
    xn = _layernorm(x, axis=-1)
    s = _A_ref(xn, A_k_cache, A_v_cache, A_wq, A_wo)
    g = _silu(_B_ref(xn, B_w1, B_b1, B_w2, B_b2))
    return x + s * g
```

```asm
; @launch grid=(256,1,1) block=(576,1,1) lds=163840
.amdgcn_target "amdgcn-amd-amdhsa--gfx950"
.text
.globl recurrent_scan__sliding_block_cached__dense_activation_gelu__decode_kernel
.p2align 8
.type recurrent_scan__sliding_block_cached__dense_activation_gelu__decode_kernel,@function
recurrent_scan__sliding_block_cached__dense_activation_gelu__decode_kernel:
    s_cmp_ge_u32 s2, 256
    s_cbranch_scc1 L_end
    s_load_dwordx16 s[4:19], s[0:1], 0
    s_load_dwordx8 s[20:27], s[0:1], 64
    s_load_dwordx2 s[28:29], s[0:1], 96
    v_and_b32 v1, 63, v0
    v_lshrrev_b32 v18, 6, v0
    v_and_b32 v2, 15, v0
    v_readfirstlane_b32 s80, v18
    v_lshrrev_b32 v3, 4, v1
    v_lshrrev_b32 v4, 2, v2
    v_and_b32 v5, 3, v0
    v_mov_b32 v6, 0
    v_mov_b32 v7, 1
    v_mov_b32 v10, 0
    v_mov_b32 v11, 131072
    s_sub_u32 s80, s80, 1
    s_cselect_b32 s80, 8, s80
    s_mov_b32 s81, 1000000
    s_mov_b32 s97, 0
    s_and_b32 s78, s2, 7
    s_lshr_b32 s79, s2, 3
    s_and_b32 s82, s79, 3
    s_and_b32 s91, s78, 3
    s_lshr_b32 s92, s78, 2
    s_lshr_b32 s93, s79, 2
    s_lshr_b32 s94, s79, 3
    s_add_u32 s83, s91, 1
    s_and_b32 s83, s83, 3
    s_lshl_b32 s83, s83, 1
    s_add_u32 s83, s83, s92
    s_lshl3_add_u32 s83, s83, s93
    s_lshl2_add_u32 s86, s92, s94
    s_and_b32 s88, s79, 7
    s_xor_b32 s85, s91, 2
    s_lshl2_add_u32 s85, s88, s85
    s_add_u32 s84, s91, 3
    s_and_b32 s84, s84, 3
    s_lshl2_add_u32 s95, s88, s84
    s_lshl2_add_u32 s84, s93, s84
    s_lshl1_add_u32 s84, s84, s92
    s_lshl2_add_u32 s87, s91, s94
    s_lshl3_add_u32 s88, s92, s88
    s_sub_u32 s89, s93, 1
    s_max_i32 s89, s89, 0
    s_lshl2_add_u32 s89, s89, s91
    s_lshl2_add_u32 s90, s92, s82
    s_xor_b32 s96, s78, 4
    s_lshl_b32 s96, s96, 5
    s_add_u32 s96, s96, s79
    s_cmp_eq_u32 s80, 8
    s_cbranch_scc1 L_loader
    s_waitcnt lgkmcnt(0)
    s_lshr_b32 s21, s78, 2
    s_lshr_b32 s94, s79, 3
    s_lshl2_add_u32 s21, s21, s94
    s_load_dwordx2 s[76:77], s[28:29], 4096
    s_mov_b32 s32, s4
    s_and_b32 s33, s5, 0xffff
    s_mov_b32 s34, 16384
    s_mov_b32 s35, 0x20000
    v_lshlrev_b32 v18, 5, v1
    s_lshl_b32 s91, s80, 11
    buffer_load_dwordx4 v[34:37], v18, s[32:35], s91 offen
    buffer_load_dwordx4 v[38:41], v18, s[32:35], s91 offen offset:16
    s_barrier
    s_branch L_comp
L_loader:
    s_setprio 3
    v_and_b32 v32, 1, v3
    v_lshlrev_b32 v32, 1, v32
    v_and_b32 v34, 7, v1
    v_xor_b32 v32, v32, v34
    v_lshlrev_b32 v32, 4, v32
    v_lshrrev_b32 v34, 3, v1
    v_lshl_add_u32 v18, v34, 13, v32
    v_xor_b32 v19, 64, v18
    v_lshl_add_u32 v22, v34, 11, v32
    v_xor_b32 v23, 64, v22
    v_mul_u32_u24 v20, 7168, v34
    v_add_u32 v20, v20, v32
    v_xor_b32 v21, 64, v20
    s_lshl_b32 s91, s82, 21
    s_lshl_b32 s92, s83, 7
    s_add_u32 s91, s91, s92
    v_lshl_add_u32 v34, v1, 2, v11
    s_mov_b64 exec, 0xffff
    ds_write_b32 v34, v6 offset:17536
    s_mov_b64 exec, -1
    s_mov_b32 s31, 0
    s_waitcnt lgkmcnt(0)
    s_mov_b32 s44, s10
    s_and_b32 s45, s11, 0xffff
    s_mov_b32 s46, 8388608
    s_mov_b32 s47, 0x20000
    s_add_u32 m0, s31, 0
    s_add_u32 s92, s91, 0
    buffer_load_dwordx4 v18, s[44:47], s92 offen nt lds
    s_add_u32 m0, s31, 1024
    s_add_u32 s92, s91, 65536
    buffer_load_dwordx4 v19, s[44:47], s92 offen nt lds
    s_add_u32 m0, s31, 2048
    s_add_u32 s92, s91, 131072
    buffer_load_dwordx4 v18, s[44:47], s92 offen nt lds
    s_add_u32 m0, s31, 3072
    s_add_u32 s92, s91, 196608
    buffer_load_dwordx4 v19, s[44:47], s92 offen nt lds
    s_add_u32 s91, s91, 262144
    s_add_u32 s31, s31, 4096
    s_add_u32 m0, s31, 0
    s_add_u32 s92, s91, 0
    buffer_load_dwordx4 v18, s[44:47], s92 offen nt lds
    s_add_u32 m0, s31, 1024
    s_add_u32 s92, s91, 65536
    buffer_load_dwordx4 v19, s[44:47], s92 offen nt lds
    s_add_u32 m0, s31, 2048
    s_add_u32 s92, s91, 131072
    buffer_load_dwordx4 v18, s[44:47], s92 offen nt lds
    s_add_u32 m0, s31, 3072
    s_add_u32 s92, s91, 196608
    buffer_load_dwordx4 v19, s[44:47], s92 offen nt lds
    s_add_u32 s91, s91, 262144
    s_add_u32 s31, s31, 4096
    s_add_u32 m0, s31, 0
    s_add_u32 s92, s91, 0
    buffer_load_dwordx4 v18, s[44:47], s92 offen nt lds
    s_add_u32 m0, s31, 1024
    s_add_u32 s92, s91, 65536
    buffer_load_dwordx4 v19, s[44:47], s92 offen nt lds
    s_add_u32 m0, s31, 2048
    s_add_u32 s92, s91, 131072
    buffer_load_dwordx4 v18, s[44:47], s92 offen nt lds
    s_add_u32 m0, s31, 3072
    s_add_u32 s92, s91, 196608
    buffer_load_dwordx4 v19, s[44:47], s92 offen nt lds
    s_add_u32 s91, s91, 262144
    s_add_u32 s31, s31, 4096
    s_add_u32 m0, s31, 0
    s_add_u32 s92, s91, 0
    buffer_load_dwordx4 v18, s[44:47], s92 offen nt lds
    s_add_u32 m0, s31, 1024
    s_add_u32 s92, s91, 65536
    buffer_load_dwordx4 v19, s[44:47], s92 offen nt lds
    s_add_u32 m0, s31, 2048
    s_add_u32 s92, s91, 131072
    buffer_load_dwordx4 v18, s[44:47], s92 offen nt lds
    s_add_u32 m0, s31, 3072
    s_add_u32 s92, s91, 196608
    buffer_load_dwordx4 v19, s[44:47], s92 offen nt lds
    s_add_u32 s91, s91, 262144
    s_add_u32 s31, s31, 4096
    s_barrier
    s_mov_b32 s36, s6
    s_and_b32 s37, s7, 0xffff
    s_mov_b32 s38, 33554432
    s_mov_b32 s39, 0x20000
    s_mov_b32 s40, s8
    s_and_b32 s41, s9, 0xffff
    s_mov_b32 s42, 33554432
    s_mov_b32 s43, 0x20000
    s_mov_b32 s48, s16
    s_and_b32 s49, s17, 0xffff
    s_mov_b32 s50, 7340032
    s_mov_b32 s51, 0x20000
    s_mov_b32 s52, s12
    s_and_b32 s53, s13, 0xffff
    s_mov_b32 s54, 8388608
    s_mov_b32 s55, 0x20000
    s_mov_b32 s56, s20
    s_and_b32 s57, s21, 0xffff
    s_mov_b32 s58, 7340032
    s_mov_b32 s59, 0x20000
    s_mov_b32 s60, s28
    s_and_b32 s61, s29, 0xffff
    s_mov_b32 s62, 268435456
    s_mov_b32 s63, 0x20000
    v_xor_b32 v32, v2, v3
    v_lshlrev_b32 v32, 4, v32
    v_lshl_add_u32 v24, v3, 8, v32
    v_xor_b32 v25, 64, v24
    v_xor_b32 v26, 128, v24
    v_xor_b32 v27, 192, v24
    v_lshlrev_b32 v32, 1, v3
    v_xor_b32 v32, v32, v2
    v_lshlrev_b32 v32, 4, v32
    v_lshl_add_u32 v28, v3, 8, v32
    v_xor_b32 v29, 128, v28
    v_lshl_add_u32 v30, v3, 11, v32
    v_xor_b32 v31, 128, v30
    s_mov_b32 s95, 16
    s_mov_b32 s96, 0
    s_lshl_b32 s5, s85, 20
    s_lshl_b32 s92, s86, 15
    s_add_u32 s5, s5, s92
    s_add_u32 s5, s5, 786432
    s_mov_b32 s17, s5
    s_lshr_b32 s92, s85, 2
    s_add_u32 s92, s92, s86
    s_and_b32 s92, s92, 7
    s_lshl_b32 s92, s92, 12
    s_add_u32 s5, s5, s92
    s_mov_b32 s6, s5
    s_mul_i32 s7, s82, 1835008
    s_lshl_b32 s92, s84, 7
    s_add_u32 s7, s7, s92
    s_lshl_b32 s8, s89, 18
    s_lshl_b32 s92, s90, 8
    s_add_u32 s8, s8, s92
    s_lshl_b32 s9, s87, 19
    s_lshl_b32 s92, s88, 7
    s_add_u32 s9, s9, s92
    s_mov_b32 s11, 32768
    s_mov_b32 s12, 65536
    s_mov_b32 s13, 98304
    s_mov_b32 s14, 0
    s_mov_b32 s15, 32768
    s_mov_b32 s4, s91
    s_mov_b32 s10, s31
    s_mov_b32 s30, 4
LL_90:
    s_add_u32 m0, s10, 0
    s_add_u32 s95, s95, 4
    buffer_load_dwordx4 v18, s[44:47], s4 offen nt lds
    s_add_u32 m0, s10, 1024
    s_add_u32 s92, s4, 65536
    buffer_load_dwordx4 v19, s[44:47], s92 offen nt lds
    s_add_u32 m0, s10, 2048
    s_add_u32 s92, s4, 131072
    buffer_load_dwordx4 v18, s[44:47], s92 offen nt lds
    s_add_u32 m0, s10, 3072
    s_add_u32 s92, s4, 196608
    buffer_load_dwordx4 v19, s[44:47], s92 offen nt lds
    s_add_u32 s4, s4, 262144
    s_add_u32 s10, s10, 4096
    s_sub_u32 s93, s95, 16
    s_max_i32 s96, s96, s93
    v_mov_b32 v33, s96
    s_waitcnt vmcnt(16)
    s_mov_b64 exec, 1
    ds_write_b32 v11, v33 offset:17536
    s_mov_b64 exec, -1
    s_sub_u32 s30, s30, 1
    s_cmp_lg_u32 s30, 0
    s_cbranch_scc1 LL_90
    s_mov_b32 s30, 8
LL_91:
    s_mov_b32 m0, s11
    s_add_u32 s95, s95, 4
    buffer_load_dwordx4 v24, s[36:39], s5 offen offset:0 nt lds
    buffer_load_dwordx4 v25, s[36:39], s5 offen offset:1024 nt lds
    buffer_load_dwordx4 v26, s[36:39], s5 offen offset:2048 nt lds
    buffer_load_dwordx4 v27, s[36:39], s5 offen offset:3072 nt lds
    s_add_u32 s5, s5, 4096
    s_and_b32 s5, s5, 32767
    s_or_b32 s5, s5, s17
    s_add_u32 s11, s11, 4096
    s_sub_u32 s93, s95, 16
    s_max_i32 s96, s96, s93
    v_mov_b32 v33, s96
    s_waitcnt vmcnt(16)
    s_mov_b64 exec, 1
    ds_write_b32 v11, v33 offset:17536
    s_mov_b64 exec, -1
    s_sub_u32 s30, s30, 1
    s_cmp_lg_u32 s30, 0
    s_cbranch_scc1 LL_91
    s_mov_b32 s30, 8
LL_92:
    s_mov_b32 m0, s12
    s_add_u32 s95, s95, 4
    buffer_load_dwordx4 v28, s[40:43], s6 offen offset:0 nt lds
    buffer_load_dwordx4 v29, s[40:43], s6 offen offset:1024 nt lds
    buffer_load_dwordx4 v28, s[40:43], s6 offen offset:2048 nt lds
    buffer_load_dwordx4 v29, s[40:43], s6 offen offset:3072 nt lds
    s_add_u32 s6, s6, 4096
    s_and_b32 s6, s6, 32767
    s_or_b32 s6, s6, s17
    s_add_u32 s12, s12, 4096
    s_sub_u32 s93, s95, 16
    s_max_i32 s96, s96, s93
    v_mov_b32 v33, s96
    s_waitcnt vmcnt(16)
    s_mov_b64 exec, 1
    ds_write_b32 v11, v33 offset:17536
    s_mov_b64 exec, -1
    s_sub_u32 s30, s30, 1
    s_cmp_lg_u32 s30, 0
    s_cbranch_scc1 LL_92
    s_cmp_ge_u32 s79, 28
    s_cbranch_scc1 SK_93
    s_mov_b32 s30, 8
LL_95:
    s_add_u32 m0, s13, 0
    s_add_u32 s95, s95, 4
    buffer_load_dwordx4 v20, s[48:51], s7 offen nt lds
    s_add_u32 m0, s13, 1024
    s_add_u32 s92, s7, 57344
    buffer_load_dwordx4 v21, s[48:51], s92 offen nt lds
    s_add_u32 m0, s13, 2048
    s_add_u32 s92, s7, 114688
    buffer_load_dwordx4 v20, s[48:51], s92 offen nt lds
    s_add_u32 m0, s13, 3072
    s_add_u32 s92, s7, 172032
    buffer_load_dwordx4 v21, s[48:51], s92 offen nt lds
    s_add_u32 s7, s7, 229376
    s_add_u32 s13, s13, 4096
    s_sub_u32 s93, s95, 16
    s_max_i32 s96, s96, s93
    v_mov_b32 v33, s96
    s_waitcnt vmcnt(16)
    s_mov_b64 exec, 1
    ds_write_b32 v11, v33 offset:17536
    s_mov_b64 exec, -1
    s_sub_u32 s30, s30, 1
    s_cmp_lg_u32 s30, 0
    s_cbranch_scc1 LL_95
    s_branch SN_94
SK_93:
    s_sub_u32 s93, s95, 12
    s_max_i32 s96, s96, s93
    v_mov_b32 v33, s96
    s_waitcnt vmcnt(12)
    s_mov_b64 exec, 1
    ds_write_b32 v11, v33 offset:17536
    s_mov_b64 exec, -1
    s_sub_u32 s93, s95, 8
    s_max_i32 s96, s96, s93
    v_mov_b32 v33, s96
    s_waitcnt vmcnt(8)
    s_mov_b64 exec, 1
    ds_write_b32 v11, v33 offset:17536
    s_mov_b64 exec, -1
    s_sub_u32 s93, s95, 4
    s_max_i32 s96, s96, s93
    v_mov_b32 v33, s96
    s_waitcnt vmcnt(4)
    s_mov_b64 exec, 1
    ds_write_b32 v11, v33 offset:17536
    s_mov_b64 exec, -1
    s_sub_u32 s93, s95, 0
    s_max_i32 s96, s96, s93
    v_mov_b32 v33, s96
    s_waitcnt vmcnt(0)
    s_mov_b64 exec, 1
    ds_write_b32 v11, v33 offset:17536
    s_mov_b64 exec, -1
    s_add_u32 s95, s95, 32
    s_sub_u32 s93, s95, 0
    s_max_i32 s96, s96, s93
    v_mov_b32 v33, s96
    s_waitcnt vmcnt(0)
    s_mov_b64 exec, 1
    ds_write_b32 v11, v33 offset:17536
    s_mov_b64 exec, -1
SN_94:
    s_cmp_lt_u32 s79, 4
    s_cbranch_scc1 SK_96
W_98:
    ds_read_b32 v32, v11 offset:17544
    s_waitcnt lgkmcnt(0)
    v_readfirstlane_b32 s94, v32
    s_cmp_ge_i32 s94, 2
    s_cbranch_scc1 D_99
    s_sub_u32 s81, s81, 1
    s_cmp_gt_i32 s81, 0
    s_cbranch_scc1 W_98
D_99:
    s_mov_b32 s30, 8
LL_100:
    s_add_u32 m0, s14, 0
    s_add_u32 s95, s95, 4
    buffer_load_dwordx4 v30, s[56:59], s8 offen nt lds
    s_add_u32 m0, s14, 1024
    s_add_u32 s92, s8, 8192
    buffer_load_dwordx4 v30, s[56:59], s92 offen nt lds
    s_add_u32 m0, s14, 2048
    s_add_u32 s92, s8, 16384
    buffer_load_dwordx4 v31, s[56:59], s92 offen nt lds
    s_add_u32 m0, s14, 3072
    s_add_u32 s92, s8, 24576
    buffer_load_dwordx4 v31, s[56:59], s92 offen nt lds
    s_add_u32 s8, s8, 32768
    s_add_u32 s14, s14, 4096
    s_sub_u32 s93, s95, 16
    s_max_i32 s96, s96, s93
    v_mov_b32 v33, s96
    s_waitcnt vmcnt(16)
    s_mov_b64 exec, 1
    ds_write_b32 v11, v33 offset:17536
    s_mov_b64 exec, -1
    s_sub_u32 s30, s30, 1
    s_cmp_lg_u32 s30, 0
    s_cbranch_scc1 LL_100
    s_branch SN_97
SK_96:
    s_sub_u32 s93, s95, 12
    s_max_i32 s96, s96, s93
    v_mov_b32 v33, s96
    s_waitcnt vmcnt(12)
    s_mov_b64 exec, 1
    ds_write_b32 v11, v33 offset:17536
    s_mov_b64 exec, -1
    s_sub_u32 s93, s95, 8
    s_max_i32 s96, s96, s93
    v_mov_b32 v33, s96
    s_waitcnt vmcnt(8)
    s_mov_b64 exec, 1
    ds_write_b32 v11, v33 offset:17536
    s_mov_b64 exec, -1
    s_sub_u32 s93, s95, 4
    s_max_i32 s96, s96, s93
    v_mov_b32 v33, s96
    s_waitcnt vmcnt(4)
    s_mov_b64 exec, 1
    ds_write_b32 v11, v33 offset:17536
    s_mov_b64 exec, -1
    s_sub_u32 s93, s95, 0
    s_max_i32 s96, s96, s93
    v_mov_b32 v33, s96
    s_waitcnt vmcnt(0)
    s_mov_b64 exec, 1
    ds_write_b32 v11, v33 offset:17536
    s_mov_b64 exec, -1
    s_add_u32 s95, s95, 32
    s_sub_u32 s93, s95, 0
    s_max_i32 s96, s96, s93
    v_mov_b32 v33, s96
    s_waitcnt vmcnt(0)
    s_mov_b64 exec, 1
    ds_write_b32 v11, v33 offset:17536
    s_mov_b64 exec, -1
SN_97:
W_101:
    ds_read_b32 v32, v11 offset:17552
    s_waitcnt lgkmcnt(0)
    v_readfirstlane_b32 s94, v32
    s_cmp_ge_i32 s94, 8
    s_cbranch_scc1 D_102
    s_sub_u32 s81, s81, 1
    s_cmp_gt_i32 s81, 0
    s_cbranch_scc1 W_101
D_102:
    s_mov_b32 s30, 8
LL_103:
    s_add_u32 m0, s15, 0
    s_add_u32 s95, s95, 4
    buffer_load_dwordx4 v22, s[52:55], s9 offen nt lds
    s_add_u32 m0, s15, 1024
    s_add_u32 s92, s9, 16384
    buffer_load_dwordx4 v23, s[52:55], s92 offen nt lds
    s_add_u32 m0, s15, 2048
    s_add_u32 s92, s9, 32768
    buffer_load_dwordx4 v22, s[52:55], s92 offen nt lds
    s_add_u32 m0, s15, 3072
    s_add_u32 s92, s9, 49152
    buffer_load_dwordx4 v23, s[52:55], s92 offen nt lds
    s_add_u32 s9, s9, 65536
    s_add_u32 s15, s15, 4096
    s_sub_u32 s93, s95, 16
    s_max_i32 s96, s96, s93
    v_mov_b32 v33, s96
    s_waitcnt vmcnt(16)
    s_mov_b64 exec, 1
    ds_write_b32 v11, v33 offset:17536
    s_mov_b64 exec, -1
    s_sub_u32 s30, s30, 1
    s_cmp_lg_u32 s30, 0
    s_cbranch_scc1 LL_103
    s_sub_u32 s93, s95, 12
    s_max_i32 s96, s96, s93
    v_mov_b32 v33, s96
    s_waitcnt vmcnt(12)
    s_mov_b64 exec, 1
    ds_write_b32 v11, v33 offset:17536
    s_mov_b64 exec, -1
    s_sub_u32 s93, s95, 8
    s_max_i32 s96, s96, s93
    v_mov_b32 v33, s96
    s_waitcnt vmcnt(8)
    s_mov_b64 exec, 1
    ds_write_b32 v11, v33 offset:17536
    s_mov_b64 exec, -1
    s_sub_u32 s93, s95, 4
    s_max_i32 s96, s96, s93
    v_mov_b32 v33, s96
    s_waitcnt vmcnt(4)
    s_mov_b64 exec, 1
    ds_write_b32 v11, v33 offset:17536
    s_mov_b64 exec, -1
    s_sub_u32 s93, s95, 0
    s_max_i32 s96, s96, s93
    v_mov_b32 v33, s96
    s_waitcnt vmcnt(0)
    s_mov_b64 exec, 1
    ds_write_b32 v11, v33 offset:17536
    s_mov_b64 exec, -1
L_end:
    s_endpgm
L_comp:
    s_mov_b32 s60, s28
    s_and_b32 s61, s29, 0xffff
    s_mov_b32 s62, 268435456
    s_mov_b32 s63, 0x20000
    s_mov_b32 s64, s24
    s_and_b32 s65, s25, 0xffff
    s_mov_b32 s66, 16384
    s_mov_b32 s67, 0x20000
    s_mov_b32 s68, s18
    s_and_b32 s69, s19, 0xffff
    s_mov_b32 s70, 7168
    s_mov_b32 s71, 0x20000
    s_mov_b32 s72, s22
    s_and_b32 s73, s23, 0xffff
    s_mov_b32 s74, 2048
    s_mov_b32 s75, 0x20000
    v_and_b32 v19, 31, v1
    v_lshlrev_b32 v19, 3, v19
    s_lshl_b32 s92, s89, 8
    buffer_load_dwordx2 v[12:13], v19, s[68:71], s92 offen
    v_and_b32 v21, 7, v1
    v_lshlrev_b32 v21, 11, v21
    s_lshl_b32 s93, s96, 3
    buffer_load_dwordx2 v[14:15], v21, s[32:35], s93 offen
    buffer_load_dwordx2 v[16:17], v6, s[72:75], s93 offen
    s_mov_b32 s22, 0x07060501
    s_mov_b32 s23, 0x07060502
    s_mov_b32 s24, 0x07060503
    s_mov_b32 s25, 0x0c04000c
    s_waitcnt vmcnt(3)
    v_lshlrev_b32 v42, 16, v34
    v_and_b32 v43, 0xffff0000, v34
    v_lshlrev_b32 v44, 16, v35
    v_and_b32 v45, 0xffff0000, v35
    v_lshlrev_b32 v46, 16, v36
    v_and_b32 v47, 0xffff0000, v36
    v_lshlrev_b32 v48, 16, v37
    v_and_b32 v49, 0xffff0000, v37
    v_lshlrev_b32 v50, 16, v38
    v_and_b32 v51, 0xffff0000, v38
    v_lshlrev_b32 v52, 16, v39
    v_and_b32 v53, 0xffff0000, v39
    v_lshlrev_b32 v54, 16, v40
    v_and_b32 v55, 0xffff0000, v40
    v_lshlrev_b32 v56, 16, v41
    v_and_b32 v57, 0xffff0000, v41
    v_add_f32 v18, v42, v43
    v_add_f32 v19, v44, v45
    v_add_f32 v18, v18, v46
    v_add_f32 v19, v19, v47
    v_add_f32 v18, v18, v48
    v_add_f32 v19, v19, v49
    v_add_f32 v18, v18, v50
    v_add_f32 v19, v19, v51
    v_add_f32 v18, v18, v52
    v_add_f32 v19, v19, v53
    v_add_f32 v18, v18, v54
    v_add_f32 v19, v19, v55
    v_add_f32 v18, v18, v56
    v_add_f32 v19, v19, v57
    v_add_f32 v18, v18, v19
    s_nop 1
    v_add_f32_dpp v18, v18, v18 quad_perm:[1,0,3,2] row_mask:0xf bank_mask:0xf
    s_nop 1
    v_add_f32_dpp v18, v18, v18 quad_perm:[2,3,0,1] row_mask:0xf bank_mask:0xf
    s_nop 1
    v_add_f32_dpp v18, v18, v18 row_ror:4 row_mask:0xf bank_mask:0xf
    s_nop 1
    v_add_f32_dpp v18, v18, v18 row_ror:8 row_mask:0xf bank_mask:0xf
    v_mov_b32 v19, v18
    s_nop 1
    v_permlane16_swap_b32 v18, v19
    v_add_f32 v18, v18, v19
    v_mov_b32 v19, v18
    s_nop 1
    v_permlane32_swap_b32 v18, v19
    v_add_f32 v18, v18, v19
    v_mul_f32 v18, 0x3a800000, v18
    v_cvt_pk_bf16_f32 v20, v18, v18
    v_lshlrev_b32 v20, 16, v20
    v_sub_f32 v19, v42, v18
    v_mul_f32 v23, v19, v19
    v_sub_f32 v19, v43, v18
    v_mul_f32 v24, v19, v19
    v_sub_f32 v19, v44, v18
    v_fma_f32 v23, v19, v19, v23
    v_sub_f32 v21, v45, v18
    v_fma_f32 v24, v21, v21, v24
    v_sub_f32 v19, v46, v18
    v_fma_f32 v23, v19, v19, v23
    v_sub_f32 v21, v47, v18
    v_fma_f32 v24, v21, v21, v24
    v_sub_f32 v19, v48, v18
    v_fma_f32 v23, v19, v19, v23
    v_sub_f32 v21, v49, v18
    v_fma_f32 v24, v21, v21, v24
    v_sub_f32 v19, v50, v18
    v_fma_f32 v23, v19, v19, v23
    v_sub_f32 v21, v51, v18
    v_fma_f32 v24, v21, v21, v24
    v_sub_f32 v19, v52, v18
    v_fma_f32 v23, v19, v19, v23
    v_sub_f32 v21, v53, v18
    v_fma_f32 v24, v21, v21, v24
    v_sub_f32 v19, v54, v18
    v_fma_f32 v23, v19, v19, v23
    v_sub_f32 v21, v55, v18
    v_fma_f32 v24, v21, v21, v24
    v_sub_f32 v19, v56, v18
    v_fma_f32 v23, v19, v19, v23
    v_sub_f32 v21, v57, v18
    v_fma_f32 v24, v21, v21, v24
    v_add_f32 v23, v23, v24
    s_nop 1
    v_add_f32_dpp v23, v23, v23 quad_perm:[1,0,3,2] row_mask:0xf bank_mask:0xf
    s_nop 1
    v_add_f32_dpp v23, v23, v23 quad_perm:[2,3,0,1] row_mask:0xf bank_mask:0xf
    s_nop 1
    v_add_f32_dpp v23, v23, v23 row_ror:4 row_mask:0xf bank_mask:0xf
    s_nop 1
    v_add_f32_dpp v23, v23, v23 row_ror:8 row_mask:0xf bank_mask:0xf
    v_mov_b32 v19, v23
    s_nop 1
    v_permlane16_swap_b32 v23, v19
    v_add_f32 v23, v23, v19
    v_mov_b32 v19, v23
    s_nop 1
    v_permlane32_swap_b32 v23, v19
    v_add_f32 v23, v23, v19
    v_mul_f32 v23, 0x3a800000, v23
    v_cvt_pk_bf16_f32 v23, v23, v23
    v_lshlrev_b32 v23, 16, v23
    v_add_f32 v23, 0x3727c5ac, v23
    v_cvt_pk_bf16_f32 v23, v23, v23
    v_lshlrev_b32 v23, 16, v23
    v_sqrt_f32 v22, v23
    s_nop 0
    v_cvt_pk_bf16_f32 v22, v22, v22
    v_lshlrev_b32 v22, 16, v22
    v_rcp_f32 v21, v22
    v_sub_f32 v42, v42, v20
    v_sub_f32 v43, v43, v20
    v_cvt_pk_bf16_f32 v19, v42, v43
    v_lshlrev_b32 v42, 16, v19
    v_and_b32 v43, 0xffff0000, v19
    v_sub_f32 v44, v44, v20
    v_sub_f32 v45, v45, v20
    v_cvt_pk_bf16_f32 v19, v44, v45
    v_lshlrev_b32 v44, 16, v19
    v_and_b32 v45, 0xffff0000, v19
    v_sub_f32 v46, v46, v20
    v_sub_f32 v47, v47, v20
    v_cvt_pk_bf16_f32 v19, v46, v47
    v_lshlrev_b32 v46, 16, v19
    v_and_b32 v47, 0xffff0000, v19
    v_sub_f32 v48, v48, v20
    v_sub_f32 v49, v49, v20
    v_cvt_pk_bf16_f32 v19, v48, v49
    v_lshlrev_b32 v48, 16, v19
    v_and_b32 v49, 0xffff0000, v19
    v_sub_f32 v50, v50, v20
    v_sub_f32 v51, v51, v20
    v_cvt_pk_bf16_f32 v19, v50, v51
    v_lshlrev_b32 v50, 16, v19
    v_and_b32 v51, 0xffff0000, v19
    v_sub_f32 v52, v52, v20
    v_sub_f32 v53, v53, v20
    v_cvt_pk_bf16_f32 v19, v52, v53
    v_lshlrev_b32 v52, 16, v19
    v_and_b32 v53, 0xffff0000, v19
    v_sub_f32 v54, v54, v20
    v_sub_f32 v55, v55, v20
    v_cvt_pk_bf16_f32 v19, v54, v55
    v_lshlrev_b32 v54, 16, v19
    v_and_b32 v55, 0xffff0000, v19
    v_sub_f32 v56, v56, v20
    v_sub_f32 v57, v57, v20
    v_cvt_pk_bf16_f32 v19, v56, v57
    v_lshlrev_b32 v56, 16, v19
    v_and_b32 v57, 0xffff0000, v19
    v_mul_f32 v23, v42, v21
    v_fma_f32 v24, -v23, v22, v42
    v_fma_f32 v42, v24, v21, v23
    v_mul_f32 v23, v43, v21
    v_fma_f32 v24, -v23, v22, v43
    v_fma_f32 v43, v24, v21, v23
    v_mul_f32 v23, v44, v21
    v_fma_f32 v24, -v23, v22, v44
    v_fma_f32 v44, v24, v21, v23
    v_mul_f32 v23, v45, v21
    v_fma_f32 v24, -v23, v22, v45
    v_fma_f32 v45, v24, v21, v23
    v_mul_f32 v23, v46, v21
    v_fma_f32 v24, -v23, v22, v46
    v_fma_f32 v46, v24, v21, v23
    v_mul_f32 v23, v47, v21
    v_fma_f32 v24, -v23, v22, v47
    v_fma_f32 v47, v24, v21, v23
    v_mul_f32 v23, v48, v21
    v_fma_f32 v24, -v23, v22, v48
    v_fma_f32 v48, v24, v21, v23
    v_mul_f32 v23, v49, v21
    v_fma_f32 v24, -v23, v22, v49
    v_fma_f32 v49, v24, v21, v23
    v_mul_f32 v23, v50, v21
    v_fma_f32 v24, -v23, v22, v50
    v_fma_f32 v50, v24, v21, v23
    v_mul_f32 v23, v51, v21
    v_fma_f32 v24, -v23, v22, v51
    v_fma_f32 v51, v24, v21, v23
    v_mul_f32 v23, v52, v21
    v_fma_f32 v24, -v23, v22, v52
    v_fma_f32 v52, v24, v21, v23
    v_mul_f32 v23, v53, v21
    v_fma_f32 v24, -v23, v22, v53
    v_fma_f32 v53, v24, v21, v23
    v_mul_f32 v23, v54, v21
    v_fma_f32 v24, -v23, v22, v54
    v_fma_f32 v54, v24, v21, v23
    v_mul_f32 v23, v55, v21
    v_fma_f32 v24, -v23, v22, v55
    v_fma_f32 v55, v24, v21, v23
    v_mul_f32 v23, v56, v21
    v_fma_f32 v24, -v23, v22, v56
    v_fma_f32 v56, v24, v21, v23
    v_mul_f32 v23, v57, v21
    v_fma_f32 v24, -v23, v22, v57
    v_fma_f32 v57, v24, v21, v23
    v_cvt_pk_bf16_f32 v34, v42, v43
    v_cvt_pk_bf16_f32 v35, v44, v45
    v_cvt_pk_bf16_f32 v36, v46, v47
    v_cvt_pk_bf16_f32 v37, v48, v49
    v_cvt_pk_bf16_f32 v38, v50, v51
    v_cvt_pk_bf16_f32 v39, v52, v53
    v_cvt_pk_bf16_f32 v40, v54, v55
    v_cvt_pk_bf16_f32 v41, v56, v57
    s_mul_i32 s91, s80, 528
    s_add_u32 s91, s91, 131072
    v_lshlrev_b32 v18, 5, v2
    v_add_u32 v18, s91, v18
    s_lshl_b32 s92, s82, 4
    s_lshl_b64 exec, 0xffff, s92
    ds_write_b128 v18, v[34:37] offset:0
    ds_write_b128 v18, v[38:41] offset:16
    s_mov_b64 exec, 1
    ds_add_u32 v11, v7 offset:17540
    s_mov_b64 exec, -1
    s_waitcnt lgkmcnt(0)
    s_add_u32 s76, s76, 1
    s_addc_u32 s77, s77, 0
    v_mov_b32 v8, s76
    v_mov_b32 v9, s77
    s_mov_b32 s44, 0x3db504f3
    s_mov_b32 s45, 0x3db504f3
    s_mov_b32 s46, 0x3fb8aa3b
    s_mov_b32 s47, 0x3fb8aa3b
    s_mov_b32 s50, 0xbdd2d3e8
    s_mov_b32 s51, 0xbdd2d3e8
    s_mov_b32 s52, 0xc0135761
    s_mov_b32 s53, 0xc0135761
    s_mov_b32 s54, 1.0
    s_mov_b32 s55, 1.0
    s_mov_b32 s56, 0xbfb8aa3b
    s_mov_b32 s57, 0xbfb8aa3b
    s_mov_b32 s48, 0
    v_and_b32 v18, 1, v3
    v_lshlrev_b32 v18, 1, v18
    v_lshrrev_b32 v19, 1, v3
    v_add_u32 v19, v19, v18
    v_lshlrev_b32 v120, 9, v19
    v_lshl_add_u32 v120, v2, 4, v120
    s_lshl3_add_u32 s36, s85, s80
    s_lshl_b32 s36, s36, 11
    s_add_u32 s36, s36, 65536
    v_and_b32 v18, 31, v1
    s_mul_i32 s93, s80, 272
    s_add_u32 s93, s93, 131072
    v_lshl_add_u32 v121, v18, 3, s93
    v_xor_b32 v122, v3, v2
    v_lshlrev_b32 v122, 4, v122
    v_lshl_add_u32 v122, v2, 8, v122
    s_lshl_b32 s91, s80, 12
    s_add_u32 s91, s91, 32768
    v_add_u32 v122, s91, v122
    v_xor_b32 v123, 64, v122
    v_xor_b32 v124, 128, v122
    v_xor_b32 v125, 192, v122
    v_and_b32 v19, 7, v2
    v_mul_u32_u24 v126, 272, v19
    v_lshl_add_u32 v126, v3, 4, v126
    v_add_u32 v126, v11, v126
    v_lshl_add_u32 v129, v1, 4, v11
    s_lshr_b32 s91, s80, 1
    s_lshl_b32 s91, s91, 10
    s_and_b32 s92, s80, 1
    s_lshl3_add_u32 s91, s92, s91
    v_add_u32 v127, s91, v129
    v_mul_u32_u24 v130, 80, v19
    v_add_u32 v130, 141568, v130
    s_lshl_b32 s91, s80, 2
    v_add_u32 v128, s91, v130
    v_and_b32 v18, 1, v3
    v_lshl_add_u32 v18, v18, 2, v4
    v_lshlrev_b32 v18, 5, v18
    s_lshl_b32 s91, s80, 5
    v_lshl_add_u32 v131, v5, 3, s91
    v_xor_b32 v131, v131, v18
    v_lshl_add_u32 v18, v3, 2, v4
    v_lshl_add_u32 v131, v18, 8, v131
    v_add_u32 v131, 65536, v131
    v_cmp_gt_u32 vcc, 8, v2
    v_lshlrev_b32 v132, 4, v2
    v_lshl_add_u32 v132, v3, 7, v132
    v_lshlrev_b32 v18, 4, v2
    v_add_u32 v18, 384, v18
    v_cndmask_b32 v132, v18, v132, vcc
    s_mul_i32 s37, s85, 40960
    s_mul_i32 s92, s80, 5120
    s_add_u32 s37, s37, s92
    s_mul_i32 s92, s86, 640
    s_add_u32 s37, s37, s92
    s_add_u32 s37, s37, 1048576
    v_not_b32 v142, v8
    v_mov_b32 v146, v8
    v_mov_b32 v147, v9
    v_lshlrev_b32 v141, 4, v1
    s_cmp_ge_u32 s80, 4
    s_cbranch_scc1 L_h1b
    v_lshrrev_b32 v18, 3, v1
    v_lshlrev_b32 v133, 9, v18
    v_and_b32 v19, 7, v1
    v_lshl_add_u32 v133, v19, 4, v133
    s_lshl_b32 s38, s80, 15
    s_lshr_b32 s92, s87, 2
    s_lshl_b32 s92, s92, 12
    s_add_u32 s38, s38, s92
    s_and_b32 s92, s87, 3
    s_lshl_b32 s92, s92, 7
    s_add_u32 s38, s38, s92
    s_add_u32 s38, s38, 2359296
    s_add_u32 s39, s38, 16384
    v_and_b32 v134, 4, v1
    v_lshlrev_b32 v134, 6, v134
    v_lshl_add_u32 v134, v18, 5, v134
    v_lshl_add_u32 v134, v5, 3, v134
    s_mul_i32 s93, s80, 1056
    s_add_u32 s93, s93, 131072
    v_add_u32 v134, s93, v134
    v_lshrrev_b32 v18, 1, v4
    v_and_b32 v135, 1, v3
    v_lshl_add_u32 v18, v135, 1, v18
    v_xor_b32 v18, s80, v18
    v_lshlrev_b32 v18, 5, v18
    v_lshl_add_u32 v18, v5, 3, v18
    v_lshl_add_u32 v135, v3, 3, v4
    v_lshl_add_u32 v135, v135, 7, v18
    v_mov_b32 v136, v135
    v_and_b32 v137, 7, v2
    v_mul_u32_u24 v137, 528, v137
    v_lshl_add_u32 v137, v3, 4, v137
    v_add_u32 v137, v11, v137
    v_mul_u32_u24 v138, 5632, v3
    v_lshl_add_u32 v138, v2, 4, v138
    s_lshl2_add_u32 s40, s88, s80
    s_mul_i32 s40, s40, 22528
    s_lshl_b32 s92, s87, 7
    s_add_u32 s40, s40, s92
    s_add_u32 s40, s40, 2621440
    v_lshrrev_b32 v18, 5, v1
    v_mul_u32_u24 v18, 640, v18
    v_and_b32 v139, 31, v1
    v_lshl_add_u32 v139, v139, 4, v18
    v_and_b32 v19, 7, v1
    v_lshl_add_u32 v140, v19, 4, v18
    v_bfe_u32 v141, v1, 3, 2
    v_lshlrev_b32 v141, 4, v141
    v_lshl_add_u32 v141, v19, 6, v141
    s_mul_i32 s41, s95, 40960
    s_mul_i32 s92, s21, 5120
    s_add_u32 s41, s41, s92
    s_add_u32 s41, s41, 1048576
    s_add_u32 s42, s41, 512
    s_lshl_b32 s43, s95, 12
    s_lshl_b32 s92, s21, 9
    s_add_u32 s43, s43, s92
    s_add_u32 s43, s43, 2359296
    s_branch L_h1done
L_h1b:
    v_lshrrev_b32 v18, 5, v1
    v_mul_u32_u24 v133, 57344, v18
    v_and_b32 v19, 1, v3
    v_lshl_add_u32 v133, v19, 10, v133
    v_lshl_add_u32 v133, v2, 4, v133
    s_mul_i32 s38, s80, 114688
    s_lshl_b32 s92, s89, 11
    s_add_u32 s38, s38, s92
    s_add_u32 s38, s38, 131072
    s_mov_b32 s39, s38
    v_mul_u32_u24 v134, 272, v18
    v_and_b32 v18, 31, v1
    v_lshl_add_u32 v134, v18, 3, v134
    s_mul_i32 s92, s80, 544
    s_add_u32 s92, s92, 128896
    v_add_u32 v134, s92, v134
    s_sub_u32 s93, s80, 4
    s_lshl_b32 s92, s93, 1
    v_lshl_add_u32 v18, v19, 2, v4
    v_xor_b32 v18, s92, v18
    v_lshlrev_b32 v18, 5, v18
    v_lshl_add_u32 v18, v5, 3, v18
    v_lshl_add_u32 v135, v3, 3, v4
    v_lshl_add_u32 v135, v135, 8, v18
    v_xor_b32 v136, 32, v135
    v_mov_b32 v137, v126
    v_lshrrev_b32 v138, 3, v2
    v_lshl_add_u32 v138, v138, 2, v3
    v_mul_u32_u24 v138, 5632, v138
    v_and_b32 v18, 7, v2
    v_lshl_add_u32 v138, v18, 4, v138
    s_lshl2_add_u32 s40, s90, s93
    s_mul_i32 s40, s40, 45056
    s_lshl_b32 s92, s89, 7
    s_add_u32 s40, s40, s92
    s_add_u32 s40, s40, 2623488
    v_mov_b32 v139, v141
    v_lshlrev_b32 v140, 11, v1
    s_mul_i32 s42, s96, 5632
    s_add_u32 s42, s42, 2621440
    s_add_u32 s41, s42, 2048
    s_lshl_b32 s43, s96, 3
L_h1done:
    s_cmp_ge_u32 s80, 2
    s_cbranch_scc1 L_qg
    s_sub_u32 s93, s80, 0
    s_lshl_b32 s92, s93, 1
    v_lshrrev_b32 v21, 1, v4
    v_and_b32 v18, 1, v3
    v_lshl_add_u32 v21, v18, 1, v21
    v_xor_b32 v21, s92, v21
    v_lshlrev_b32 v21, 5, v21
    v_lshl_add_u32 v21, v5, 3, v21
    v_lshl_add_u32 v18, v3, 3, v4
    v_lshl_add_u32 v18, v18, 7, v21
    v_xor_b32 v19, 32, v18
    v_and_b32 v20, 7, v2
    v_mul_u32_u24 v20, 528, v20
    v_lshl_add_u32 v20, v3, 4, v20
    v_add_u32 v20, v11, v20
W_1:
    ds_read_b32 v21, v11 offset:17540
    s_waitcnt lgkmcnt(0)
    v_readfirstlane_b32 s94, v21
    s_cmp_ge_i32 s94, 8
    s_cbranch_scc1 D_2
    s_sub_u32 s81, s81, 1
    s_cmp_gt_i32 s81, 0
    s_cbranch_scc1 W_1
D_2:
    ds_read_b128 v[22:25], v20 offset:0
    ds_read_b128 v[26:29], v20 offset:64
    ds_read_b128 v[30:33], v20 offset:128
    ds_read_b128 v[34:37], v20 offset:192
    ds_read_b128 v[38:41], v20 offset:256
    ds_read_b128 v[42:45], v20 offset:320
    ds_read_b128 v[46:49], v20 offset:384
    ds_read_b128 v[50:53], v20 offset:448
    v_and_b32 v94, 7, v2
    v_mul_u32_u24 v94, 65536, v94
    v_and_b32 v21, 8, v2
    v_lshl_add_u32 v94, v21, 3, v94
    v_lshl_add_u32 v94, v3, 4, v94
    s_lshl_b32 s91, s83, 10
    s_lshl_b32 s92, s82, 8
    s_add_u32 s91, s91, s92
    s_lshl_b32 s92, s93, 7
    s_add_u32 s91, s91, s92
    s_add_u32 s91, s91, 65536
    v_cmp_gt_u32 vcc, 8, v2
W_3:
    s_cmp_ge_i32 s97, 16
    s_cbranch_scc1 D_4
    ds_read_b32 v21, v11 offset:17536
    s_sub_u32 s81, s81, 1
    s_waitcnt lgkmcnt(0)
    v_readfirstlane_b32 s97, v21
    s_cmp_gt_i32 s81, 0
    s_cbranch_scc1 W_3
D_4:
    ds_read_b64_tr_b16 v[54:55], v18 offset:0
    ds_read_b64_tr_b16 v[56:57], v18 offset:512
    ds_read_b64_tr_b16 v[58:59], v19 offset:0
    ds_read_b64_tr_b16 v[60:61], v19 offset:512
    ds_read_b64_tr_b16 v[62:63], v18 offset:4096
    ds_read_b64_tr_b16 v[64:65], v18 offset:4608
    ds_read_b64_tr_b16 v[66:67], v19 offset:4096
    ds_read_b64_tr_b16 v[68:69], v19 offset:4608
    ds_read_b64_tr_b16 v[70:71], v18 offset:8192
    ds_read_b64_tr_b16 v[72:73], v18 offset:8704
    ds_read_b64_tr_b16 v[74:75], v19 offset:8192
    ds_read_b64_tr_b16 v[76:77], v19 offset:8704
    ds_read_b64_tr_b16 v[78:79], v18 offset:12288
    ds_read_b64_tr_b16 v[80:81], v18 offset:12800
    ds_read_b64_tr_b16 v[82:83], v19 offset:12288
    ds_read_b64_tr_b16 v[84:85], v19 offset:12800
    s_waitcnt lgkmcnt(14)
    v_mfma_f32_16x16x32_bf16 v[86:89], v[54:57], v[22:25], 0
    s_waitcnt lgkmcnt(12)
    v_mfma_f32_16x16x32_bf16 v[90:93], v[58:61], v[22:25], 0
    s_waitcnt lgkmcnt(10)
    v_mfma_f32_16x16x32_bf16 v[86:89], v[62:65], v[26:29], v[86:89]
    s_waitcnt lgkmcnt(8)
    v_mfma_f32_16x16x32_bf16 v[90:93], v[66:69], v[26:29], v[90:93]
    s_waitcnt lgkmcnt(6)
    v_mfma_f32_16x16x32_bf16 v[86:89], v[70:73], v[30:33], v[86:89]
    s_waitcnt lgkmcnt(4)
    v_mfma_f32_16x16x32_bf16 v[90:93], v[74:77], v[30:33], v[90:93]
    s_waitcnt lgkmcnt(2)
    v_mfma_f32_16x16x32_bf16 v[86:89], v[78:81], v[34:37], v[86:89]
    s_waitcnt lgkmcnt(0)
    v_mfma_f32_16x16x32_bf16 v[90:93], v[82:85], v[34:37], v[90:93]
W_5:
    s_cmp_ge_i32 s97, 24
    s_cbranch_scc1 D_6
    ds_read_b32 v21, v11 offset:17536
    s_sub_u32 s81, s81, 1
    s_waitcnt lgkmcnt(0)
    v_readfirstlane_b32 s97, v21
    s_cmp_gt_i32 s81, 0
    s_cbranch_scc1 W_5
D_6:
    ds_read_b64_tr_b16 v[54:55], v18 offset:16384
    ds_read_b64_tr_b16 v[56:57], v18 offset:16896
    ds_read_b64_tr_b16 v[58:59], v19 offset:16384
    ds_read_b64_tr_b16 v[60:61], v19 offset:16896
    ds_read_b64_tr_b16 v[62:63], v18 offset:20480
    ds_read_b64_tr_b16 v[64:65], v18 offset:20992
    ds_read_b64_tr_b16 v[66:67], v19 offset:20480
    ds_read_b64_tr_b16 v[68:69], v19 offset:20992
    s_waitcnt lgkmcnt(6)
    v_mfma_f32_16x16x32_bf16 v[86:89], v[54:57], v[38:41], v[86:89]
    s_waitcnt lgkmcnt(4)
    v_mfma_f32_16x16x32_bf16 v[90:93], v[58:61], v[38:41], v[90:93]
    s_waitcnt lgkmcnt(2)
    v_mfma_f32_16x16x32_bf16 v[86:89], v[62:65], v[42:45], v[86:89]
    s_waitcnt lgkmcnt(0)
    v_mfma_f32_16x16x32_bf16 v[90:93], v[66:69], v[42:45], v[90:93]
W_7:
    s_cmp_ge_i32 s97, 28
    s_cbranch_scc1 D_8
    ds_read_b32 v21, v11 offset:17536
    s_sub_u32 s81, s81, 1
    s_waitcnt lgkmcnt(0)
    v_readfirstlane_b32 s97, v21
    s_cmp_gt_i32 s81, 0
    s_cbranch_scc1 W_7
D_8:
    ds_read_b64_tr_b16 v[54:55], v18 offset:24576
    ds_read_b64_tr_b16 v[56:57], v18 offset:25088
    ds_read_b64_tr_b16 v[58:59], v19 offset:24576
    ds_read_b64_tr_b16 v[60:61], v19 offset:25088
    s_waitcnt lgkmcnt(2)
    v_mfma_f32_16x16x32_bf16 v[86:89], v[54:57], v[46:49], v[86:89]
    s_waitcnt lgkmcnt(0)
    v_mfma_f32_16x16x32_bf16 v[90:93], v[58:61], v[46:49], v[90:93]
W_9:
    s_cmp_ge_i32 s97, 32
    s_cbranch_scc1 D_10
    ds_read_b32 v21, v11 offset:17536
    s_sub_u32 s81, s81, 1
    s_waitcnt lgkmcnt(0)
    v_readfirstlane_b32 s97, v21
    s_cmp_gt_i32 s81, 0
    s_cbranch_scc1 W_9
D_10:
    ds_read_b64_tr_b16 v[54:55], v18 offset:28672
    ds_read_b64_tr_b16 v[56:57], v18 offset:29184
    ds_read_b64_tr_b16 v[58:59], v19 offset:28672
    ds_read_b64_tr_b16 v[60:61], v19 offset:29184
    s_waitcnt lgkmcnt(2)
    v_mfma_f32_16x16x32_bf16 v[86:89], v[54:57], v[50:53], v[86:89]
    s_waitcnt lgkmcnt(0)
    v_mfma_f32_16x16x32_bf16 v[90:93], v[58:61], v[50:53], v[90:93]
    s_nop 7
    s_nop 1
    v_cndmask_b32 v86, v90, v86, vcc
    v_cndmask_b32 v87, v91, v87, vcc
    v_cndmask_b32 v88, v92, v88, vcc
    v_cndmask_b32 v89, v93, v89, vcc
    v_add_u32 v89, 0x80, v89
    v_perm_b32 v86, v86, v89, s22
    v_perm_b32 v87, v87, v89, s23
    v_perm_b32 v88, v88, v89, s24
    v_mov_b32 v89, v8
    buffer_store_dwordx4 v[86:89], v94, s[60:63], s91 offen sc1
    s_mov_b64 exec, 1
    ds_add_u32 v11, v7 offset:17544
    s_mov_b64 exec, -1
    s_waitcnt vmcnt(0)
    s_mov_b64 exec, 1
    ds_add_u32 v11, v7 offset:17592
    s_mov_b64 exec, -1
L_qg:
W_11:
    ds_read_b32 v18, v11 offset:17592
    s_waitcnt lgkmcnt(0)
    v_readfirstlane_b32 s94, v18
    s_cmp_ge_i32 s94, 2
    s_cbranch_scc1 D_12
    s_sub_u32 s81, s81, 1
    s_cmp_gt_i32 s81, 0
    s_cbranch_scc1 W_11
D_12:
W_13:
    s_cmp_ge_i32 s97, 40
    s_cbranch_scc1 D_14
    ds_read_b32 v18, v11 offset:17536
    s_sub_u32 s81, s81, 1
    s_waitcnt lgkmcnt(0)
    v_readfirstlane_b32 s97, v18
    s_cmp_gt_i32 s81, 0
    s_cbranch_scc1 W_13
D_14:
    buffer_load_dwordx4 v[62:65], v120, s[60:63], s36 offen offset:0
    buffer_load_dwordx4 v[66:69], v120, s[60:63], s36 offen offset:256
    s_waitcnt vmcnt(0)
    v_cmp_ne_u32 s[4:5], s76, v65
    v_cmp_ne_u32 s[6:7], s76, v69
    s_or_b64 s[100:101], s[4:5], s[6:7]
    s_cbranch_scc0 PD_16
P_15:
    s_wqm_b64 exec, s[4:5]
    s_cbranch_execz K_17
    buffer_load_dwordx4 v[62:65], v120, s[60:63], s36 offen offset:0 sc1
K_17:
    s_wqm_b64 exec, s[6:7]
    s_cbranch_execz K_18
    buffer_load_dwordx4 v[66:69], v120, s[60:63], s36 offen offset:256 sc1
K_18:
    s_mov_b64 exec, -1
    s_cmp_lg_u32 s48, 0
    s_cbranch_scc1 OP_19
    ds_read_b32 v18, v11 offset:17536
    s_waitcnt lgkmcnt(0)
    v_readfirstlane_b32 s97, v18
    s_cmp_lt_i32 s97, 64
    s_cbranch_scc1 OP_19
    ds_read_b128 v[22:25], v122
    ds_read_b128 v[26:29], v123
    ds_read_b128 v[30:33], v124
    ds_read_b128 v[34:37], v125
    s_mov_b32 s48, 1
OP_19:
    s_sub_u32 s81, s81, 16
    s_waitcnt vmcnt(0)
    v_cmp_ne_u32 s[4:5], s76, v65
    v_cmp_ne_u32 s[6:7], s76, v69
    s_or_b64 s[100:101], s[4:5], s[6:7]
    s_cbranch_scc0 PD_16
    s_cmp_gt_i32 s81, 0
    s_cbranch_scc1 P_15
PD_16:
    v_perm_b32 v65, v63, v62, s25
    v_lshl_or_b32 v65, v64, 24, v65
    v_perm_b32 v69, v67, v66, s25
    v_lshl_or_b32 v69, v68, 24, v69
    v_pk_add_f32 v[62:63], v[62:63], v[66:67]
    v_pk_add_f32 v[64:65], v[64:65], v[68:69]
    v_mov_b32 v66, v62
    v_mov_b32 v67, v63
    v_mov_b32 v68, v64
    v_mov_b32 v69, v65
    v_permlane32_swap_b32 v62, v66
    v_permlane32_swap_b32 v63, v67
    v_permlane32_swap_b32 v64, v68
    v_permlane32_swap_b32 v65, v69
    v_add_f32 v62, v62, v66
    v_add_f32 v63, v63, v67
    v_add_f32 v64, v64, v68
    v_add_f32 v65, v65, v69
    v_cvt_pk_bf16_f32 v62, v62, v63
    v_cvt_pk_bf16_f32 v63, v64, v65
    s_mov_b64 exec, 0xffffffff
    ds_write_b64 v121, v[62:63] offset:4224
    s_mov_b64 exec, 1
    ds_add_u32 v11, v7 offset:17548
    s_mov_b64 exec, -1
    s_lshl_b32 s91, s80, 2
    s_add_u32 s91, s91, 36
    s_cmp_lg_u32 s48, 0
    s_cbranch_scc1 MU_20
W_21:
    s_cmp_ge_i32 s97, s91
    s_cbranch_scc1 D_22
    ds_read_b32 v18, v11 offset:17536
    s_sub_u32 s81, s81, 1
    s_waitcnt lgkmcnt(0)
    v_readfirstlane_b32 s97, v18
    s_cmp_gt_i32 s81, 0
    s_cbranch_scc1 W_21
D_22:
    ds_read_b128 v[22:25], v122
    ds_read_b128 v[26:29], v123
    ds_read_b128 v[30:33], v124
    ds_read_b128 v[34:37], v125
MU_20:
    s_mov_b32 s48, 0
W_23:
    ds_read_b32 v18, v11 offset:17548
    s_waitcnt lgkmcnt(0)
    v_readfirstlane_b32 s94, v18
    s_cmp_ge_i32 s94, 8
    s_cbranch_scc1 D_24
    s_sub_u32 s81, s81, 1
    s_cmp_gt_i32 s81, 0
    s_cbranch_scc1 W_23
D_24:
    ds_read_b128 v[38:41], v126 offset:4224
    ds_read_b128 v[42:45], v126 offset:4288
    ds_read_b128 v[46:49], v126 offset:4352
    ds_read_b128 v[50:53], v126 offset:4416
    s_waitcnt lgkmcnt(3)
    v_mfma_f32_16x16x32_bf16 v[54:57], v[22:25], v[38:41], 0
    s_waitcnt lgkmcnt(2)
    v_mfma_f32_16x16x32_bf16 v[54:57], v[26:29], v[42:45], v[54:57]
    s_waitcnt lgkmcnt(1)
    v_mfma_f32_16x16x32_bf16 v[54:57], v[30:33], v[46:49], v[54:57]
    s_waitcnt lgkmcnt(0)
    v_mfma_f32_16x16x32_bf16 v[54:57], v[34:37], v[50:53], v[54:57]
    s_nop 7
    s_nop 1
    v_cvt_pk_bf16_f32 v18, v54, v55
    v_cvt_pk_bf16_f32 v19, v56, v57
    v_lshlrev_b32 v54, 16, v18
    v_and_b32 v55, 0xffff0000, v18
    v_lshlrev_b32 v56, 16, v19
    v_and_b32 v57, 0xffff0000, v19
    v_pk_mul_f32 v[54:55], v[54:55], s[44:45]
    v_pk_mul_f32 v[56:57], v[56:57], s[44:45]
    v_cvt_pk_bf16_f32 v18, v54, v55
    v_cvt_pk_bf16_f32 v19, v56, v57
    v_lshlrev_b32 v54, 16, v18
    v_and_b32 v55, 0xffff0000, v18
    v_lshlrev_b32 v56, 16, v19
    v_and_b32 v57, 0xffff0000, v19
    v_max_f32 v58, v54, v55
    v_max3_f32 v58, v56, v57, v58
    v_mov_b32 v18, v58
    s_nop 1
    v_permlane16_swap_b32 v58, v18
    v_max_f32 v58, v58, v18
    v_mov_b32 v18, v58
    s_nop 1
    v_permlane32_swap_b32 v58, v18
    v_max_f32 v58, v58, v18
    v_mul_f32 v58, s46, v58
    v_pk_fma_f32 v[54:55], v[54:55], s[46:47], v[58:59] op_sel_hi:[1,1,0] neg_lo:[0,0,1] neg_hi:[0,0,1]
    v_pk_fma_f32 v[56:57], v[56:57], s[46:47], v[58:59] op_sel_hi:[1,1,0] neg_lo:[0,0,1] neg_hi:[0,0,1]
    v_exp_f32 v54, v54
    v_exp_f32 v55, v55
    v_exp_f32 v56, v56
    v_exp_f32 v57, v57
    s_nop 0
    v_cvt_pk_bf16_f32 v60, v54, v55
    v_cvt_pk_bf16_f32 v61, v56, v57
    ds_write_b64 v127, v[60:61] offset:6400
    v_pk_add_f32 v[54:55], v[54:55], v[56:57]
    v_add_f32 v59, v54, v55
    v_mov_b32 v18, v59
    s_nop 1
    v_permlane16_swap_b32 v59, v18
    v_add_f32 v59, v59, v18
    v_mov_b32 v18, v59
    s_nop 1
    v_permlane32_swap_b32 v59, v18
    v_add_f32 v59, v59, v18
    s_mov_b64 exec, 0xff
    ds_write2_b32 v128, v58, v59 offset0:0 offset1:8
    s_mov_b64 exec, 1
    ds_add_u32 v11, v7 offset:17552
    s_mov_b64 exec, -1
W_25:
    s_cmp_ge_i32 s97, 96
    s_cbranch_scc1 D_26
    ds_read_b32 v18, v11 offset:17536
    s_sub_u32 s81, s81, 1
    s_waitcnt lgkmcnt(0)
    v_readfirstlane_b32 s97, v18
    s_cmp_gt_i32 s81, 0
    s_cbranch_scc1 W_25
D_26:
    ds_read_b64_tr_b16 v[62:63], v131 offset:0
    ds_read_b64_tr_b16 v[64:65], v131 offset:4096
    ds_read_b64_tr_b16 v[66:67], v131 offset:8192
    ds_read_b64_tr_b16 v[68:69], v131 offset:12288
    ds_read_b64_tr_b16 v[70:71], v131 offset:16384
    ds_read_b64_tr_b16 v[72:73], v131 offset:20480
    ds_read_b64_tr_b16 v[74:75], v131 offset:24576
    ds_read_b64_tr_b16 v[76:77], v131 offset:28672
    v_cmp_gt_u32 vcc, 8, v2
W_27:
    ds_read_b32 v18, v11 offset:17552
    s_waitcnt lgkmcnt(0)
    v_readfirstlane_b32 s94, v18
    s_cmp_ge_i32 s94, 8
    s_cbranch_scc1 D_28
    s_sub_u32 s81, s81, 1
    s_cmp_gt_i32 s81, 0
    s_cbranch_scc1 W_27
D_28:
    ds_read_b128 v[38:41], v130 offset:0
    ds_read_b128 v[42:45], v130 offset:16
    ds_read_b128 v[22:25], v129 offset:6400
    ds_read_b128 v[26:29], v129 offset:7424
    ds_read_b128 v[30:33], v129 offset:8448
    ds_read_b128 v[34:37], v129 offset:9472
    ds_read_b128 v[46:49], v130 offset:32
    ds_read_b128 v[50:53], v130 offset:48
    s_waitcnt lgkmcnt(6)
    v_max3_f32 v54, v38, v39, v40
    v_max3_f32 v18, v41, v42, v43
    v_max3_f32 v54, v54, v44, v45
    v_max_f32 v54, v54, v18
    s_waitcnt lgkmcnt(5)
    v_mfma_f32_16x16x16_bf16 v[78:81], v[62:63], v[22:23], 0
    v_mfma_f32_16x16x16_bf16 v[82:85], v[64:65], v[24:25], 0
    v_pk_add_f32 v[38:39], v[38:39], v[54:55] op_sel_hi:[1,0] neg_lo:[0,1] neg_hi:[0,1]
    v_exp_f32 v38, v38
    v_exp_f32 v39, v39
    s_waitcnt lgkmcnt(4)
    v_mfma_f32_16x16x16_bf16 v[86:89], v[66:67], v[26:27], 0
    v_mfma_f32_16x16x16_bf16 v[90:93], v[68:69], v[28:29], 0
    v_pk_add_f32 v[40:41], v[40:41], v[54:55] op_sel_hi:[1,0] neg_lo:[0,1] neg_hi:[0,1]
    v_exp_f32 v40, v40
    v_exp_f32 v41, v41
    s_waitcnt lgkmcnt(3)
    v_mfma_f32_16x16x16_bf16 v[94:97], v[70:71], v[30:31], 0
    v_mfma_f32_16x16x16_bf16 v[98:101], v[72:73], v[32:33], 0
    v_pk_add_f32 v[42:43], v[42:43], v[54:55] op_sel_hi:[1,0] neg_lo:[0,1] neg_hi:[0,1]
    v_exp_f32 v42, v42
    v_exp_f32 v43, v43
    s_waitcnt lgkmcnt(2)
    v_mfma_f32_16x16x16_bf16 v[102:105], v[74:75], v[34:35], 0
    v_mfma_f32_16x16x16_bf16 v[106:109], v[76:77], v[36:37], 0
    v_pk_add_f32 v[44:45], v[44:45], v[54:55] op_sel_hi:[1,0] neg_lo:[0,1] neg_hi:[0,1]
    v_exp_f32 v44, v44
    v_exp_f32 v45, v45
    s_waitcnt lgkmcnt(0)
    v_pk_mul_f32 v[56:57], v[38:39], v[46:47]
    v_pk_fma_f32 v[56:57], v[40:41], v[48:49], v[56:57]
    v_pk_fma_f32 v[56:57], v[42:43], v[50:51], v[56:57]
    v_pk_fma_f32 v[56:57], v[44:45], v[52:53], v[56:57]
    v_add_f32 v56, v56, v57
    v_pk_mul_f32 v[78:79], v[78:79], v[38:39] op_sel_hi:[1,0]
    v_pk_mul_f32 v[80:81], v[80:81], v[38:39] op_sel_hi:[1,0]
    v_pk_mul_f32 v[82:83], v[82:83], v[38:39] op_sel:[0,1] op_sel_hi:[1,1]
    v_pk_mul_f32 v[84:85], v[84:85], v[38:39] op_sel:[0,1] op_sel_hi:[1,1]
    v_pk_fma_f32 v[78:79], v[86:87], v[40:41], v[78:79] op_sel_hi:[1,0,1]
    v_pk_fma_f32 v[80:81], v[88:89], v[40:41], v[80:81] op_sel_hi:[1,0,1]
    v_pk_fma_f32 v[82:83], v[90:91], v[40:41], v[82:83] op_sel:[0,1,0] op_sel_hi:[1,1,1]
    v_pk_fma_f32 v[84:85], v[92:93], v[40:41], v[84:85] op_sel:[0,1,0] op_sel_hi:[1,1,1]
    v_pk_fma_f32 v[78:79], v[94:95], v[42:43], v[78:79] op_sel_hi:[1,0,1]
    v_pk_fma_f32 v[80:81], v[96:97], v[42:43], v[80:81] op_sel_hi:[1,0,1]
    v_pk_fma_f32 v[82:83], v[98:99], v[42:43], v[82:83] op_sel:[0,1,0] op_sel_hi:[1,1,1]
    v_pk_fma_f32 v[84:85], v[100:101], v[42:43], v[84:85] op_sel:[0,1,0] op_sel_hi:[1,1,1]
    s_nop 1
    v_pk_fma_f32 v[78:79], v[102:103], v[44:45], v[78:79] op_sel_hi:[1,0,1]
    v_pk_fma_f32 v[80:81], v[104:105], v[44:45], v[80:81] op_sel_hi:[1,0,1]
    v_pk_fma_f32 v[82:83], v[106:107], v[44:45], v[82:83] op_sel:[0,1,0] op_sel_hi:[1,1,1]
    v_pk_fma_f32 v[84:85], v[108:109], v[44:45], v[84:85] op_sel:[0,1,0] op_sel_hi:[1,1,1]
    v_pk_add_f32 v[78:79], v[78:79], v[82:83]
    v_pk_add_f32 v[80:81], v[80:81], v[84:85]
    v_add_u32 v81, 0x80, v81
    v_perm_b32 v78, v78, v81, s22
    v_perm_b32 v79, v79, v81, s23
    v_perm_b32 v80, v80, v81, s24
    v_mov_b32 v81, v8
    v_cndmask_b32 v78, v54, v78, vcc
    v_cndmask_b32 v79, v56, v79, vcc
    s_mov_b32 exec_lo, 0x00ffffff
    s_mov_b32 exec_hi, 0x00ff00ff
    buffer_store_dwordx4 v[78:81], v132, s[60:63], s37 offen sc1
    s_mov_b64 exec, -1
    s_cmp_ge_u32 s80, 4
    s_cbranch_scc1 L_hpath
    s_cmp_lg_u32 s80, 0
    s_cbranch_scc1 L_comb_done
    s_waitcnt vmcnt(0)
    s_mov_b32 s4, -1
    s_mov_b32 s5, -1
    s_mov_b32 s6, -1
    s_mov_b32 s7, -1
    s_mov_b32 s8, -1
    s_mov_b32 s9, -1
    s_mov_b32 s10, -1
    s_mov_b32 s11, -1
    s_mov_b32 s12, -1
    s_mov_b32 s13, -1
    s_mov_b32 s14, -1
    s_mov_b32 s15, -1
    s_mov_b32 s16, -1
    s_mov_b32 s17, -1
    s_mov_b32 s18, -1
    s_mov_b32 s19, -1
P_29:
    s_wqm_b64 exec, s[4:5]
    s_cbranch_execz K_31
    buffer_load_dwordx4 v[26:29], v139, s[60:63], s41 offen offset:0 sc1
K_31:
    s_wqm_b64 exec, s[6:7]
    s_cbranch_execz K_32
    buffer_load_dwordx4 v[30:33], v139, s[60:63], s41 offen offset:1280 sc1
K_32:
    s_wqm_b64 exec, s[8:9]
    s_cbranch_execz K_33
    buffer_load_dwordx4 v[34:37], v139, s[60:63], s41 offen offset:2560 sc1
K_33:
    s_wqm_b64 exec, s[10:11]
    s_cbranch_execz K_34
    buffer_load_dwordx4 v[38:41], v139, s[60:63], s41 offen offset:3840 sc1
K_34:
    s_wqm_b64 exec, s[12:13]
    s_cbranch_execz K_35
    buffer_load_dwordx4 v[42:45], v140, s[60:63], s42 offen offset:0 sc1
K_35:
    s_wqm_b64 exec, s[14:15]
    s_cbranch_execz K_36
    buffer_load_dwordx4 v[46:49], v140, s[60:63], s42 offen offset:1280 sc1
K_36:
    s_wqm_b64 exec, s[16:17]
    s_cbranch_execz K_37
    buffer_load_dwordx4 v[50:53], v140, s[60:63], s42 offen offset:2560 sc1
K_37:
    s_wqm_b64 exec, s[18:19]
    s_cbranch_execz K_38
    buffer_load_dwordx4 v[54:57], v140, s[60:63], s42 offen offset:3840 sc1
K_38:
    s_mov_b64 exec, -1
    s_sub_u32 s81, s81, 16
    s_waitcnt vmcnt(0)
    v_cmp_ne_u32 s[4:5], s76, v29
    v_cmp_ne_u32 s[6:7], s76, v33
    v_cmp_ne_u32 s[8:9], s76, v37
    v_cmp_ne_u32 s[10:11], s76, v41
    v_cmp_ne_u32 s[12:13], s76, v45
    v_cmp_ne_u32 s[14:15], s76, v49
    v_cmp_ne_u32 s[16:17], s76, v53
    v_cmp_ne_u32 s[18:19], s76, v57
    s_or_b64 s[100:101], s[4:5], s[6:7]
    s_or_b64 s[100:101], s[100:101], s[8:9]
    s_or_b64 s[100:101], s[100:101], s[10:11]
    s_or_b64 s[100:101], s[100:101], s[12:13]
    s_or_b64 s[100:101], s[100:101], s[14:15]
    s_or_b64 s[100:101], s[100:101], s[16:17]
    s_or_b64 s[100:101], s[100:101], s[18:19]
    s_cbranch_scc0 PD_30
    s_cmp_gt_i32 s81, 0
    s_cbranch_scc1 P_29
PD_30:
    v_max3_f32 v20, v42, v46, v50
    v_max_f32 v20, v20, v54
    v_mov_b32 v22, v20
    v_perm_b32 v29, v27, v26, s25
    v_lshl_or_b32 v29, v28, 24, v29
    v_permlane32_swap_b32 v20, v22
    v_perm_b32 v33, v31, v30, s25
    v_lshl_or_b32 v33, v32, 24, v33
    v_max_f32 v20, v20, v22
    v_sub_f32 v42, v42, v20
    v_exp_f32 v42, v42
    v_sub_f32 v46, v46, v20
    v_exp_f32 v46, v46
    v_sub_f32 v50, v50, v20
    v_exp_f32 v50, v50
    v_sub_f32 v54, v54, v20
    v_exp_f32 v54, v54
    v_perm_b32 v37, v35, v34, s25
    v_lshl_or_b32 v37, v36, 24, v37
    v_perm_b32 v41, v39, v38, s25
    v_lshl_or_b32 v41, v40, 24, v41
    v_mul_f32 v21, v42, v43
    v_pk_mul_f32 v[26:27], v[26:27], v[42:43] op_sel_hi:[1,0]
    v_pk_mul_f32 v[28:29], v[28:29], v[42:43] op_sel_hi:[1,0]
    v_fma_f32 v21, v46, v47, v21
    v_pk_fma_f32 v[26:27], v[30:31], v[46:47], v[26:27] op_sel_hi:[1,0,1]
    v_pk_fma_f32 v[28:29], v[32:33], v[46:47], v[28:29] op_sel_hi:[1,0,1]
    v_fma_f32 v21, v50, v51, v21
    v_pk_fma_f32 v[26:27], v[34:35], v[50:51], v[26:27] op_sel_hi:[1,0,1]
    v_pk_fma_f32 v[28:29], v[36:37], v[50:51], v[28:29] op_sel_hi:[1,0,1]
    v_fma_f32 v21, v54, v55, v21
    v_pk_fma_f32 v[26:27], v[38:39], v[54:55], v[26:27] op_sel_hi:[1,0,1]
    v_pk_fma_f32 v[28:29], v[40:41], v[54:55], v[28:29] op_sel_hi:[1,0,1]
    v_mov_b32 v44, v21
    v_mov_b32 v45, v26
    v_mov_b32 v48, v27
    v_mov_b32 v49, v28
    v_mov_b32 v52, v29
    v_permlane32_swap_b32 v21, v44
    v_permlane32_swap_b32 v26, v45
    v_permlane32_swap_b32 v27, v48
    v_permlane32_swap_b32 v28, v49
    v_permlane32_swap_b32 v29, v52
    v_add_f32 v21, v21, v44
    v_add_f32 v26, v26, v45
    v_add_f32 v27, v27, v48
    v_add_f32 v28, v28, v49
    v_add_f32 v29, v29, v52
    v_rcp_f32 v20, v21
    s_mov_b64 exec, 0xffffffff
    v_pk_mul_f32 v[26:27], v[26:27], v[20:21] op_sel_hi:[1,0]
    v_pk_mul_f32 v[28:29], v[28:29], v[20:21] op_sel_hi:[1,0]
    v_cvt_pk_bf16_f32 v144, v26, v27
    v_cvt_pk_bf16_f32 v145, v28, v29
    buffer_store_dwordx4 v[144:147], v141, s[60:63], s43 offen sc1
    s_mov_b64 exec, 1
    ds_add_u32 v11, v7 offset:17564
    s_mov_b64 exec, -1
    s_waitcnt vmcnt(0)
    s_mov_b64 exec, 1
    ds_add_u32 v11, v7 offset:17564
    s_mov_b64 exec, -1
L_comb_done:
W_39:
    ds_read_b32 v18, v11 offset:17564
    s_waitcnt lgkmcnt(0)
    v_readfirstlane_b32 s94, v18
    s_cmp_ge_i32 s94, 2
    s_cbranch_scc1 D_40
    s_sub_u32 s81, s81, 1
    s_cmp_gt_i32 s81, 0
    s_cbranch_scc1 W_39
D_40:
W_41:
    s_cmp_ge_i32 s97, 176
    s_cbranch_scc1 D_42
    ds_read_b32 v18, v11 offset:17536
    s_sub_u32 s81, s81, 1
    s_waitcnt lgkmcnt(0)
    v_readfirstlane_b32 s97, v18
    s_cmp_gt_i32 s81, 0
    s_cbranch_scc1 W_41
D_42:
    s_mov_b32 s4, -1
    s_mov_b32 s5, -1
    s_mov_b32 s6, -1
    s_mov_b32 s7, -1
P_43:
    s_wqm_b64 exec, s[4:5]
    s_cbranch_execz K_45
    buffer_load_dwordx4 v[94:97], v133, s[60:63], s38 offen offset:0 sc1
K_45:
    s_wqm_b64 exec, s[6:7]
    s_cbranch_execz K_46
    buffer_load_dwordx4 v[98:101], v133, s[60:63], s39 offen offset:0 sc1
K_46:
    s_mov_b64 exec, -1
    s_cmp_lg_u32 s48, 0
    s_cbranch_scc1 OP_47
    ds_read_b32 v18, v11 offset:17536
    s_waitcnt lgkmcnt(0)
    v_readfirstlane_b32 s97, v18
    s_cmp_lt_i32 s97, 192
    s_cbranch_scc1 OP_47
    ds_read_b64_tr_b16 v[22:23], v135 offset:32768
    ds_read_b64_tr_b16 v[24:25], v135 offset:33280
    ds_read_b64_tr_b16 v[26:27], v135 offset:36864
    ds_read_b64_tr_b16 v[28:29], v135 offset:37376
    ds_read_b64_tr_b16 v[30:31], v135 offset:40960
    ds_read_b64_tr_b16 v[32:33], v135 offset:41472
    ds_read_b64_tr_b16 v[34:35], v135 offset:45056
    ds_read_b64_tr_b16 v[36:37], v135 offset:45568
    ds_read_b64_tr_b16 v[38:39], v135 offset:49152
    ds_read_b64_tr_b16 v[40:41], v135 offset:49664
    ds_read_b64_tr_b16 v[42:43], v135 offset:53248
    ds_read_b64_tr_b16 v[44:45], v135 offset:53760
    ds_read_b64_tr_b16 v[46:47], v135 offset:57344
    ds_read_b64_tr_b16 v[48:49], v135 offset:57856
    ds_read_b64_tr_b16 v[50:51], v135 offset:61440
    ds_read_b64_tr_b16 v[52:53], v135 offset:61952
    s_mov_b32 s48, 1
OP_47:
    s_sub_u32 s81, s81, 16
    s_waitcnt vmcnt(0)
    v_cmp_ne_u64 s[4:5], s[76:77], v[96:97]
    v_cmp_ne_u64 s[6:7], s[76:77], v[100:101]
    s_or_b64 s[100:101], s[4:5], s[6:7]
    s_cbranch_scc0 PD_44
    s_cmp_gt_i32 s81, 0
    s_cbranch_scc1 P_43
PD_44:
    ds_write_b64 v134, v[94:95] offset:11136
    ds_write_b64 v134, v[98:99] offset:11664
    s_mov_b64 exec, 1
    ds_add_u32 v11, v7 offset:17556
    s_mov_b64 exec, -1
    s_cmp_lg_u32 s48, 0
    s_cbranch_scc1 OP_48
    ds_read_b32 v18, v11 offset:17536
    s_waitcnt lgkmcnt(0)
    v_readfirstlane_b32 s97, v18
    s_cmp_lt_i32 s97, 192
    s_cbranch_scc1 OP_48
    ds_read_b64_tr_b16 v[22:23], v135 offset:32768
    ds_read_b64_tr_b16 v[24:25], v135 offset:33280
    ds_read_b64_tr_b16 v[26:27], v135 offset:36864
    ds_read_b64_tr_b16 v[28:29], v135 offset:37376
    ds_read_b64_tr_b16 v[30:31], v135 offset:40960
    ds_read_b64_tr_b16 v[32:33], v135 offset:41472
    ds_read_b64_tr_b16 v[34:35], v135 offset:45056
    ds_read_b64_tr_b16 v[36:37], v135 offset:45568
    ds_read_b64_tr_b16 v[38:39], v135 offset:49152
    ds_read_b64_tr_b16 v[40:41], v135 offset:49664
    ds_read_b64_tr_b16 v[42:43], v135 offset:53248
    ds_read_b64_tr_b16 v[44:45], v135 offset:53760
    ds_read_b64_tr_b16 v[46:47], v135 offset:57344
    ds_read_b64_tr_b16 v[48:49], v135 offset:57856
    ds_read_b64_tr_b16 v[50:51], v135 offset:61440
    ds_read_b64_tr_b16 v[52:53], v135 offset:61952
    s_mov_b32 s48, 1
OP_48:
W_49:
    ds_read_b32 v18, v11 offset:17556
    s_waitcnt lgkmcnt(0)
    v_readfirstlane_b32 s94, v18
    s_cmp_ge_i32 s94, 4
    s_cbranch_scc1 D_50
    s_sub_u32 s81, s81, 1
    s_cmp_gt_i32 s81, 0
    s_cbranch_scc1 W_49
D_50:
    ds_read_b128 v[54:57], v137 offset:11136
    ds_read_b128 v[58:61], v137 offset:11200
    ds_read_b128 v[62:65], v137 offset:11264
    ds_read_b128 v[66:69], v137 offset:11328
    ds_read_b128 v[70:73], v137 offset:11392
    ds_read_b128 v[74:77], v137 offset:11456
    ds_read_b128 v[78:81], v137 offset:11520
    ds_read_b128 v[82:85], v137 offset:11584
    s_cmp_lg_u32 s48, 0
    s_cbranch_scc1 L_wo_fast
W_51:
    s_cmp_ge_i32 s97, 184
    s_cbranch_scc1 D_52
    ds_read_b32 v18, v11 offset:17536
    s_sub_u32 s81, s81, 1
    s_waitcnt lgkmcnt(0)
    v_readfirstlane_b32 s97, v18
    s_cmp_gt_i32 s81, 0
    s_cbranch_scc1 W_51
D_52:
    ds_read_b64_tr_b16 v[22:23], v135 offset:32768
    ds_read_b64_tr_b16 v[24:25], v135 offset:33280
    ds_read_b64_tr_b16 v[26:27], v135 offset:36864
    ds_read_b64_tr_b16 v[28:29], v135 offset:37376
    ds_read_b64_tr_b16 v[30:31], v135 offset:40960
    ds_read_b64_tr_b16 v[32:33], v135 offset:41472
    ds_read_b64_tr_b16 v[34:35], v135 offset:45056
    ds_read_b64_tr_b16 v[36:37], v135 offset:45568
    ds_read_b64_tr_b16 v[38:39], v135 offset:49152
    ds_read_b64_tr_b16 v[40:41], v135 offset:49664
    ds_read_b64_tr_b16 v[42:43], v135 offset:53248
    ds_read_b64_tr_b16 v[44:45], v135 offset:53760
    s_waitcnt lgkmcnt(10)
    v_mfma_f32_16x16x32_bf16 v[86:89], v[22:25], v[54:57], 0
    s_waitcnt lgkmcnt(8)
    v_mfma_f32_16x16x32_bf16 v[90:93], v[26:29], v[58:61], 0
    s_waitcnt lgkmcnt(6)
    v_mfma_f32_16x16x32_bf16 v[86:89], v[30:33], v[62:65], v[86:89]
    s_waitcnt lgkmcnt(4)
    v_mfma_f32_16x16x32_bf16 v[90:93], v[34:37], v[66:69], v[90:93]
    s_waitcnt lgkmcnt(2)
    v_mfma_f32_16x16x32_bf16 v[86:89], v[38:41], v[70:73], v[86:89]
    s_waitcnt lgkmcnt(0)
    v_mfma_f32_16x16x32_bf16 v[90:93], v[42:45], v[74:77], v[90:93]
W_53:
    s_cmp_ge_i32 s97, 188
    s_cbranch_scc1 D_54
    ds_read_b32 v18, v11 offset:17536
    s_sub_u32 s81, s81, 1
    s_waitcnt lgkmcnt(0)
    v_readfirstlane_b32 s97, v18
    s_cmp_gt_i32 s81, 0
    s_cbranch_scc1 W_53
D_54:
    ds_read_b64_tr_b16 v[46:47], v135 offset:57344
    ds_read_b64_tr_b16 v[48:49], v135 offset:57856
    s_waitcnt lgkmcnt(0)
    v_mfma_f32_16x16x32_bf16 v[86:89], v[46:49], v[78:81], v[86:89]
W_55:
    s_cmp_ge_i32 s97, 192
    s_cbranch_scc1 D_56
    ds_read_b32 v18, v11 offset:17536
    s_sub_u32 s81, s81, 1
    s_waitcnt lgkmcnt(0)
    v_readfirstlane_b32 s97, v18
    s_cmp_gt_i32 s81, 0
    s_cbranch_scc1 W_55
D_56:
    ds_read_b64_tr_b16 v[50:51], v135 offset:61440
    ds_read_b64_tr_b16 v[52:53], v135 offset:61952
    s_waitcnt lgkmcnt(0)
    v_mfma_f32_16x16x32_bf16 v[90:93], v[50:53], v[82:85], v[90:93]
    s_branch L_wo_join
L_wo_fast:
    s_waitcnt lgkmcnt(7)
    v_mfma_f32_16x16x32_bf16 v[86:89], v[22:25], v[54:57], 0
    s_waitcnt lgkmcnt(6)
    v_mfma_f32_16x16x32_bf16 v[90:93], v[26:29], v[58:61], 0
    s_waitcnt lgkmcnt(5)
    v_mfma_f32_16x16x32_bf16 v[86:89], v[30:33], v[62:65], v[86:89]
    s_waitcnt lgkmcnt(4)
    v_mfma_f32_16x16x32_bf16 v[90:93], v[34:37], v[66:69], v[90:93]
    s_waitcnt lgkmcnt(3)
    v_mfma_f32_16x16x32_bf16 v[86:89], v[38:41], v[70:73], v[86:89]
    s_waitcnt lgkmcnt(2)
    v_mfma_f32_16x16x32_bf16 v[90:93], v[42:45], v[74:77], v[90:93]
    s_waitcnt lgkmcnt(1)
    v_mfma_f32_16x16x32_bf16 v[86:89], v[46:49], v[78:81], v[86:89]
    s_waitcnt lgkmcnt(0)
    v_mfma_f32_16x16x32_bf16 v[90:93], v[50:53], v[82:85], v[90:93]
L_wo_join:
    s_mov_b32 exec_lo, 0x00ff00ff
    s_mov_b32 exec_hi, 0x00ff00ff
    s_nop 7
    v_pk_add_f32 v[86:87], v[86:87], v[90:91]
    v_pk_add_f32 v[88:89], v[88:89], v[92:93]
    v_add_u32 v89, 0x80, v89
    v_perm_b32 v86, v86, v89, s22
    v_perm_b32 v87, v87, v89, s23
    v_perm_b32 v88, v88, v89, s24
    v_mov_b32 v89, v8
    buffer_store_dwordx4 v[86:89], v138, s[60:63], s40 offen sc1
    s_waitcnt vmcnt(0)
    s_mov_b64 exec, 1
    ds_add_u32 v11, v7 offset:17568
    s_mov_b64 exec, -1
    s_branch L_fin_wave
L_hpath:
    s_cmp_ge_u32 s79, 28
    s_cbranch_scc1 L_p1h_done
    s_sub_u32 s93, s80, 4
    s_lshl_b32 s92, s93, 0
    v_lshrrev_b32 v21, 1, v4
    v_and_b32 v18, 1, v3
    v_lshl_add_u32 v21, v18, 1, v21
    v_xor_b32 v21, s92, v21
    v_lshlrev_b32 v21, 5, v21
    v_lshl_add_u32 v21, v5, 3, v21
    v_lshl_add_u32 v18, v3, 3, v4
    v_lshl_add_u32 v18, v18, 7, v21
    v_add_u32 v18, 98304, v18
    v_and_b32 v20, 7, v2
    v_mul_u32_u24 v20, 528, v20
    v_lshl_add_u32 v20, v3, 4, v20
    v_add_u32 v20, v11, v20
    ds_read_b128 v[22:25], v20 offset:0
    ds_read_b128 v[26:29], v20 offset:64
    ds_read_b128 v[30:33], v20 offset:128
    ds_read_b128 v[34:37], v20 offset:192
    ds_read_b128 v[38:41], v20 offset:256
    ds_read_b128 v[42:45], v20 offset:320
    ds_read_b128 v[46:49], v20 offset:384
    ds_read_b128 v[50:53], v20 offset:448
    v_and_b32 v94, 7, v2
    v_mul_u32_u24 v94, 57344, v94
    v_lshl_add_u32 v94, v3, 4, v94
    s_lshl_b32 s91, s84, 10
    s_lshl_b32 s92, s82, 8
    s_add_u32 s91, s91, s92
    s_lshl_b32 s92, s93, 6
    s_add_u32 s91, s91, s92
    s_add_u32 s91, s91, 589824
    v_cmp_gt_u32 vcc, 8, v2
W_57:
    s_cmp_ge_i32 s97, 120
    s_cbranch_scc1 D_58
    ds_read_b32 v21, v11 offset:17536
    s_sub_u32 s81, s81, 1
    s_waitcnt lgkmcnt(0)
    v_readfirstlane_b32 s97, v21
    s_cmp_gt_i32 s81, 0
    s_cbranch_scc1 W_57
D_58:
    ds_read_b64_tr_b16 v[54:55], v18 offset:0
    ds_read_b64_tr_b16 v[56:57], v18 offset:512
    ds_read_b64_tr_b16 v[58:59], v18 offset:4096
    ds_read_b64_tr_b16 v[60:61], v18 offset:4608
    ds_read_b64_tr_b16 v[62:63], v18 offset:8192
    ds_read_b64_tr_b16 v[64:65], v18 offset:8704
    ds_read_b64_tr_b16 v[66:67], v18 offset:12288
    ds_read_b64_tr_b16 v[68:69], v18 offset:12800
    ds_read_b64_tr_b16 v[70:71], v18 offset:16384
    ds_read_b64_tr_b16 v[72:73], v18 offset:16896
    ds_read_b64_tr_b16 v[74:75], v18 offset:20480
    ds_read_b64_tr_b16 v[76:77], v18 offset:20992
    s_waitcnt lgkmcnt(10)
    v_mfma_f32_16x16x32_bf16 v[86:89], v[54:57], v[22:25], 0
    s_waitcnt lgkmcnt(8)
    v_mfma_f32_16x16x32_bf16 v[90:93], v[58:61], v[26:29], 0
    s_waitcnt lgkmcnt(6)
    v_mfma_f32_16x16x32_bf16 v[86:89], v[62:65], v[30:33], v[86:89]
    s_waitcnt lgkmcnt(4)
    v_mfma_f32_16x16x32_bf16 v[90:93], v[66:69], v[34:37], v[90:93]
    s_waitcnt lgkmcnt(2)
    v_mfma_f32_16x16x32_bf16 v[86:89], v[70:73], v[38:41], v[86:89]
    s_waitcnt lgkmcnt(0)
    v_mfma_f32_16x16x32_bf16 v[90:93], v[74:77], v[42:45], v[90:93]
W_59:
    s_cmp_ge_i32 s97, 128
    s_cbranch_scc1 D_60
    ds_read_b32 v21, v11 offset:17536
    s_sub_u32 s81, s81, 1
    s_waitcnt lgkmcnt(0)
    v_readfirstlane_b32 s97, v21
    s_cmp_gt_i32 s81, 0
    s_cbranch_scc1 W_59
D_60:
    ds_read_b64_tr_b16 v[78:79], v18 offset:24576
    ds_read_b64_tr_b16 v[80:81], v18 offset:25088
    ds_read_b64_tr_b16 v[82:83], v18 offset:28672
    ds_read_b64_tr_b16 v[84:85], v18 offset:29184
    s_waitcnt lgkmcnt(2)
    v_mfma_f32_16x16x32_bf16 v[86:89], v[78:81], v[46:49], v[86:89]
    s_waitcnt lgkmcnt(0)
    v_mfma_f32_16x16x32_bf16 v[90:93], v[82:85], v[50:53], v[90:93]
    s_nop 7
    s_nop 1
    v_pk_add_f32 v[86:87], v[86:87], v[90:91]
    v_pk_add_f32 v[88:89], v[88:89], v[92:93]
    v_add_u32 v89, 0x80, v89
    v_perm_b32 v86, v86, v89, s22
    v_perm_b32 v87, v87, v89, s23
    v_perm_b32 v88, v88, v89, s24
    v_mov_b32 v89, v8
    s_mov_b64 exec, vcc
    buffer_store_dwordx4 v[86:89], v94, s[60:63], s91 offen sc1
    s_mov_b64 exec, -1
L_p1h_done:
    s_cmp_lt_u32 s79, 4
    s_cbranch_scc1 L_h_done
    v_lshlrev_b32 v94, 16, v12
    v_and_b32 v95, 0xffff0000, v12
    v_lshlrev_b32 v96, 16, v13
    v_and_b32 v97, 0xffff0000, v13
    v_cmp_gt_u32 vcc, 8, v2
W_61:
    ds_read_b32 v18, v11 offset:17564
    s_waitcnt lgkmcnt(0)
    v_readfirstlane_b32 s94, v18
    s_cmp_ge_i32 s94, 1
    s_cbranch_scc1 D_62
    s_sub_u32 s81, s81, 1
    s_cmp_gt_i32 s81, 0
    s_cbranch_scc1 W_61
D_62:
    buffer_load_dwordx4 v[78:81], v133, s[60:63], s38 offen offset:0
    buffer_load_dwordx4 v[82:85], v133, s[60:63], s38 offen offset:256
    buffer_load_dwordx4 v[86:89], v133, s[60:63], s38 offen offset:512
    buffer_load_dwordx4 v[90:93], v133, s[60:63], s38 offen offset:768
    s_cmp_lg_u32 s48, 0
    s_cbranch_scc1 OP_65
    ds_read_b32 v18, v11 offset:17536
    s_waitcnt lgkmcnt(0)
    v_readfirstlane_b32 s97, v18
    s_cmp_lt_i32 s97, 160
    s_cbranch_scc1 OP_65
    ds_read_b64_tr_b16 v[22:23], v135 offset:0
    ds_read_b64_tr_b16 v[24:25], v135 offset:1024
    ds_read_b64_tr_b16 v[26:27], v136 offset:0
    ds_read_b64_tr_b16 v[28:29], v136 offset:1024
    ds_read_b64_tr_b16 v[30:31], v135 offset:8192
    ds_read_b64_tr_b16 v[32:33], v135 offset:9216
    ds_read_b64_tr_b16 v[34:35], v136 offset:8192
    ds_read_b64_tr_b16 v[36:37], v136 offset:9216
    ds_read_b64_tr_b16 v[38:39], v135 offset:16384
    ds_read_b64_tr_b16 v[40:41], v135 offset:17408
    ds_read_b64_tr_b16 v[42:43], v136 offset:16384
    ds_read_b64_tr_b16 v[44:45], v136 offset:17408
    ds_read_b64_tr_b16 v[46:47], v135 offset:24576
    ds_read_b64_tr_b16 v[48:49], v135 offset:25600
    ds_read_b64_tr_b16 v[50:51], v136 offset:24576
    ds_read_b64_tr_b16 v[52:53], v136 offset:25600
    s_mov_b32 s48, 1
OP_65:
    s_waitcnt vmcnt(0)
    v_cmp_ne_u32 s[4:5], s76, v81
    v_cmp_ne_u32 s[6:7], s76, v85
    v_cmp_ne_u32 s[8:9], s76, v89
    v_cmp_ne_u32 s[10:11], s76, v93
    s_or_b64 s[100:101], s[4:5], s[6:7]
    s_or_b64 s[100:101], s[100:101], s[8:9]
    s_or_b64 s[100:101], s[100:101], s[10:11]
    s_cbranch_scc0 PD_64
P_63:
    s_wqm_b64 exec, s[4:5]
    s_cbranch_execz K_66
    buffer_load_dwordx4 v[78:81], v133, s[60:63], s38 offen offset:0 sc1
K_66:
    s_wqm_b64 exec, s[6:7]
    s_cbranch_execz K_67
    buffer_load_dwordx4 v[82:85], v133, s[60:63], s38 offen offset:256 sc1
K_67:
    s_wqm_b64 exec, s[8:9]
    s_cbranch_execz K_68
    buffer_load_dwordx4 v[86:89], v133, s[60:63], s38 offen offset:512 sc1
K_68:
    s_wqm_b64 exec, s[10:11]
    s_cbranch_execz K_69
    buffer_load_dwordx4 v[90:93], v133, s[60:63], s38 offen offset:768 sc1
K_69:
    s_mov_b64 exec, -1
    s_cmp_lg_u32 s48, 0
    s_cbranch_scc1 OP_70
    ds_read_b32 v18, v11 offset:17536
    s_waitcnt lgkmcnt(0)
    v_readfirstlane_b32 s97, v18
    s_cmp_lt_i32 s97, 160
    s_cbranch_scc1 OP_70
    ds_read_b64_tr_b16 v[22:23], v135 offset:0
    ds_read_b64_tr_b16 v[24:25], v135 offset:1024
    ds_read_b64_tr_b16 v[26:27], v136 offset:0
    ds_read_b64_tr_b16 v[28:29], v136 offset:1024
    ds_read_b64_tr_b16 v[30:31], v135 offset:8192
    ds_read_b64_tr_b16 v[32:33], v135 offset:9216
    ds_read_b64_tr_b16 v[34:35], v136 offset:8192
    ds_read_b64_tr_b16 v[36:37], v136 offset:9216
    ds_read_b64_tr_b16 v[38:39], v135 offset:16384
    ds_read_b64_tr_b16 v[40:41], v135 offset:17408
    ds_read_b64_tr_b16 v[42:43], v136 offset:16384
    ds_read_b64_tr_b16 v[44:45], v136 offset:17408
    ds_read_b64_tr_b16 v[46:47], v135 offset:24576
    ds_read_b64_tr_b16 v[48:49], v135 offset:25600
    ds_read_b64_tr_b16 v[50:51], v136 offset:24576
    ds_read_b64_tr_b16 v[52:53], v136 offset:25600
    s_mov_b32 s48, 1
OP_70:
    s_sub_u32 s81, s81, 16
    s_waitcnt vmcnt(0)
    v_cmp_ne_u32 s[4:5], s76, v81
    v_cmp_ne_u32 s[6:7], s76, v85
    v_cmp_ne_u32 s[8:9], s76, v89
    v_cmp_ne_u32 s[10:11], s76, v93
    s_or_b64 s[100:101], s[4:5], s[6:7]
    s_or_b64 s[100:101], s[100:101], s[8:9]
    s_or_b64 s[100:101], s[100:101], s[10:11]
    s_cbranch_scc0 PD_64
    s_cmp_gt_i32 s81, 0
    s_cbranch_scc1 P_63
PD_64:
    v_perm_b32 v81, v79, v78, s25
    v_lshl_or_b32 v81, v80, 24, v81
    v_perm_b32 v85, v83, v82, s25
    v_lshl_or_b32 v85, v84, 24, v85
    v_perm_b32 v89, v87, v86, s25
    v_lshl_or_b32 v89, v88, 24, v89
    v_perm_b32 v93, v91, v90, s25
    v_lshl_or_b32 v93, v92, 24, v93
    v_pk_add_f32 v[78:79], v[78:79], v[82:83]
    v_pk_add_f32 v[86:87], v[86:87], v[90:91]
    v_pk_add_f32 v[80:81], v[80:81], v[84:85]
    v_pk_add_f32 v[88:89], v[88:89], v[92:93]
    v_pk_add_f32 v[78:79], v[78:79], v[86:87]
    v_pk_add_f32 v[80:81], v[80:81], v[88:89]
    v_cvt_pk_bf16_f32 v18, v78, v79
    v_cvt_pk_bf16_f32 v19, v80, v81
    v_lshlrev_b32 v78, 16, v18
    v_and_b32 v79, 0xffff0000, v18
    v_lshlrev_b32 v80, 16, v19
    v_and_b32 v81, 0xffff0000, v19
    v_pk_add_f32 v[78:79], v[78:79], v[94:95]
    v_pk_add_f32 v[80:81], v[80:81], v[96:97]
    v_cvt_pk_bf16_f32 v18, v78, v79
    v_cvt_pk_bf16_f32 v19, v80, v81
    v_lshlrev_b32 v78, 16, v18
    v_and_b32 v79, 0xffff0000, v18
    v_lshlrev_b32 v80, 16, v19
    v_and_b32 v81, 0xffff0000, v19
    v_mov_b32 v86, s52
    v_mov_b32 v87, s52
    v_pk_mul_f32 v[82:83], v[78:79], v[78:79]
    v_pk_mul_f32 v[84:85], v[80:81], v[80:81]
    v_pk_fma_f32 v[82:83], v[82:83], s[50:51], v[86:87]
    v_pk_fma_f32 v[84:85], v[84:85], s[50:51], v[86:87]
    v_pk_mul_f32 v[82:83], v[82:83], v[78:79]
    v_pk_mul_f32 v[84:85], v[84:85], v[80:81]
    v_exp_f32 v82, v82
    v_exp_f32 v83, v83
    v_exp_f32 v84, v84
    v_exp_f32 v85, v85
    s_nop 0
    v_pk_add_f32 v[82:83], v[82:83], s[54:55]
    v_pk_add_f32 v[84:85], v[84:85], s[54:55]
    v_rcp_f32 v82, v82
    v_rcp_f32 v83, v83
    v_rcp_f32 v84, v84
    v_rcp_f32 v85, v85
    s_nop 0
    v_pk_mul_f32 v[78:79], v[78:79], v[82:83]
    v_pk_mul_f32 v[80:81], v[80:81], v[84:85]
    v_cvt_pk_bf16_f32 v78, v78, v79
    v_cvt_pk_bf16_f32 v79, v80, v81
    ds_write_b64 v134, v[78:79] offset:15360
    s_mov_b64 exec, 1
    ds_add_u32 v11, v7 offset:17560
    s_mov_b64 exec, -1
    s_cmp_lg_u32 s48, 0
    s_cbranch_scc1 MU_71
W_72:
    s_cmp_ge_i32 s97, 160
    s_cbranch_scc1 D_73
    ds_read_b32 v18, v11 offset:17536
    s_sub_u32 s81, s81, 1
    s_waitcnt lgkmcnt(0)
    v_readfirstlane_b32 s97, v18
    s_cmp_gt_i32 s81, 0
    s_cbranch_scc1 W_72
D_73:
    ds_read_b64_tr_b16 v[22:23], v135 offset:0
    ds_read_b64_tr_b16 v[24:25], v135 offset:1024
    ds_read_b64_tr_b16 v[26:27], v136 offset:0
    ds_read_b64_tr_b16 v[28:29], v136 offset:1024
    ds_read_b64_tr_b16 v[30:31], v135 offset:8192
    ds_read_b64_tr_b16 v[32:33], v135 offset:9216
    ds_read_b64_tr_b16 v[34:35], v136 offset:8192
    ds_read_b64_tr_b16 v[36:37], v136 offset:9216
    ds_read_b64_tr_b16 v[38:39], v135 offset:16384
    ds_read_b64_tr_b16 v[40:41], v135 offset:17408
    ds_read_b64_tr_b16 v[42:43], v136 offset:16384
    ds_read_b64_tr_b16 v[44:45], v136 offset:17408
    ds_read_b64_tr_b16 v[46:47], v135 offset:24576
    ds_read_b64_tr_b16 v[48:49], v135 offset:25600
    ds_read_b64_tr_b16 v[50:51], v136 offset:24576
    ds_read_b64_tr_b16 v[52:53], v136 offset:25600
MU_71:
W_74:
    ds_read_b32 v18, v11 offset:17560
    s_waitcnt lgkmcnt(0)
    v_readfirstlane_b32 s94, v18
    s_cmp_ge_i32 s94, 4
    s_cbranch_scc1 D_75
    s_sub_u32 s81, s81, 1
    s_cmp_gt_i32 s81, 0
    s_cbranch_scc1 W_74
D_75:
    ds_read_b128 v[54:57], v137 offset:15360
    ds_read_b128 v[58:61], v137 offset:15424
    ds_read_b128 v[62:65], v137 offset:15488
    ds_read_b128 v[66:69], v137 offset:15552
    s_waitcnt lgkmcnt(3)
    v_mfma_f32_16x16x32_bf16 v[70:73], v[22:25], v[54:57], 0
    v_mfma_f32_16x16x32_bf16 v[74:77], v[26:29], v[54:57], 0
    s_waitcnt lgkmcnt(2)
    v_mfma_f32_16x16x32_bf16 v[70:73], v[30:33], v[58:61], v[70:73]
    v_mfma_f32_16x16x32_bf16 v[74:77], v[34:37], v[58:61], v[74:77]
    s_waitcnt lgkmcnt(1)
    v_mfma_f32_16x16x32_bf16 v[70:73], v[38:41], v[62:65], v[70:73]
    v_mfma_f32_16x16x32_bf16 v[74:77], v[42:45], v[62:65], v[74:77]
    s_waitcnt lgkmcnt(0)
    v_mfma_f32_16x16x32_bf16 v[70:73], v[46:49], v[66:69], v[70:73]
    v_mfma_f32_16x16x32_bf16 v[74:77], v[50:53], v[66:69], v[74:77]
    s_nop 7
    s_nop 1
    v_cndmask_b32 v70, v74, v70, vcc
    v_cndmask_b32 v71, v75, v71, vcc
    v_cndmask_b32 v72, v76, v72, vcc
    v_cndmask_b32 v73, v77, v73, vcc
    v_add_u32 v73, 0x80, v73
    v_perm_b32 v70, v70, v73, s22
    v_perm_b32 v71, v71, v73, s23
    v_perm_b32 v72, v72, v73, s24
    v_mov_b32 v73, v8
    buffer_store_dwordx4 v[70:73], v138, s[60:63], s40 offen sc1
L_h_done:
    s_cmp_ge_u32 s80, 5
    s_cbranch_scc1 L_fin_wave
    v_mov_b32 v42, 0
    v_mov_b32 v43, 0
    v_mov_b32 v44, 0
    v_mov_b32 v45, v8
    v_lshlrev_b32 v46, 16, v16
    v_and_b32 v47, 0xffff0000, v16
    v_lshlrev_b32 v48, 16, v17
    v_and_b32 v49, 0xffff0000, v17
    v_lshlrev_b32 v26, 16, v14
    v_and_b32 v27, 0xffff0000, v14
    v_lshlrev_b32 v28, 16, v15
    v_and_b32 v29, 0xffff0000, v15
W_76:
    ds_read_b32 v18, v11 offset:17556
    s_waitcnt lgkmcnt(0)
    v_readfirstlane_b32 s94, v18
    s_cmp_ge_i32 s94, 1
    s_cbranch_scc1 D_77
    s_sub_u32 s81, s81, 1
    s_cmp_gt_i32 s81, 0
    s_cbranch_scc1 W_76
D_77:
    s_mov_b32 s4, -1
    s_mov_b32 s5, -1
    s_mov_b32 s6, -1
    s_mov_b32 s7, -1
    s_mov_b32 s8, -1
    s_mov_b32 s9, -1
    s_mov_b32 s10, -1
    s_mov_b32 s11, 0
P_78:
    s_wqm_b64 exec, s[4:5]
    s_cbranch_execz K_80
    buffer_load_dwordx4 v[30:33], v139, s[60:63], s41 offen offset:0 sc1
K_80:
    s_wqm_b64 exec, s[6:7]
    s_cbranch_execz K_81
    buffer_load_dwordx4 v[34:37], v139, s[60:63], s41 offen offset:1024 sc1
K_81:
    s_wqm_b64 exec, s[8:9]
    s_cbranch_execz K_82
    buffer_load_dwordx4 v[38:41], v139, s[60:63], s41 offen offset:2048 sc1
K_82:
    s_wqm_b64 exec, s[10:11]
    s_cbranch_execz K_83
    buffer_load_dwordx4 v[42:45], v139, s[60:63], s41 offen offset:3072 sc1
K_83:
    s_mov_b64 exec, -1
    s_sub_u32 s81, s81, 16
    s_waitcnt vmcnt(0)
    v_cmp_ne_u32 s[4:5], s76, v33
    v_cmp_ne_u32 s[6:7], s76, v37
    v_cmp_ne_u32 s[8:9], s76, v41
    v_cmp_ne_u32 s[10:11], s76, v45
    s_or_b64 s[100:101], s[4:5], s[6:7]
    s_or_b64 s[100:101], s[100:101], s[8:9]
    s_or_b64 s[100:101], s[100:101], s[10:11]
    s_cbranch_scc0 PD_79
    s_cmp_gt_i32 s81, 0
    s_cbranch_scc1 P_78
PD_79:
    v_perm_b32 v33, v31, v30, s25
    v_lshl_or_b32 v33, v32, 24, v33
    v_perm_b32 v37, v35, v34, s25
    v_lshl_or_b32 v37, v36, 24, v37
    v_perm_b32 v41, v39, v38, s25
    v_lshl_or_b32 v41, v40, 24, v41
    v_perm_b32 v45, v43, v42, s25
    v_lshl_or_b32 v45, v44, 24, v45
    v_pk_add_f32 v[30:31], v[30:31], v[34:35]
    v_pk_add_f32 v[38:39], v[38:39], v[42:43]
    v_pk_add_f32 v[32:33], v[32:33], v[36:37]
    v_pk_add_f32 v[40:41], v[40:41], v[44:45]
    v_pk_add_f32 v[22:23], v[30:31], v[38:39]
    v_pk_add_f32 v[24:25], v[32:33], v[40:41]
    v_mov_b32 v30, v22
    v_mov_b32 v31, v23
    v_mov_b32 v32, v24
    v_mov_b32 v33, v25
    v_permlane16_swap_b32 v22, v30
    v_permlane16_swap_b32 v23, v31
    v_permlane16_swap_b32 v24, v32
    v_permlane16_swap_b32 v25, v33
    v_add_f32 v22, v22, v30
    v_add_f32 v23, v23, v31
    v_add_f32 v24, v24, v32
    v_add_f32 v25, v25, v33
    v_mov_b32 v30, v22
    v_mov_b32 v31, v23
    v_mov_b32 v32, v24
    v_mov_b32 v33, v25
    v_permlane32_swap_b32 v22, v30
    v_permlane32_swap_b32 v23, v31
    v_permlane32_swap_b32 v24, v32
    v_permlane32_swap_b32 v25, v33
    v_add_f32 v22, v22, v30
    v_add_f32 v23, v23, v31
    v_add_f32 v24, v24, v32
    v_add_f32 v25, v25, v33
    v_add_f32_dpp v22, v22, v22 row_ror:8 row_mask:0xf bank_mask:0xf
    v_add_f32_dpp v23, v23, v23 row_ror:8 row_mask:0xf bank_mask:0xf
    v_add_f32_dpp v24, v24, v24 row_ror:8 row_mask:0xf bank_mask:0xf
    v_add_f32_dpp v25, v25, v25 row_ror:8 row_mask:0xf bank_mask:0xf
    v_cvt_pk_bf16_f32 v18, v22, v23
    v_cvt_pk_bf16_f32 v19, v24, v25
    v_lshlrev_b32 v22, 16, v18
    v_and_b32 v23, 0xffff0000, v18
    v_lshlrev_b32 v24, 16, v19
    v_and_b32 v25, 0xffff0000, v19
    v_pk_add_f32 v[22:23], v[22:23], v[46:47]
    v_pk_add_f32 v[24:25], v[24:25], v[48:49]
    v_cvt_pk_bf16_f32 v18, v22, v23
    v_cvt_pk_bf16_f32 v19, v24, v25
    v_lshlrev_b32 v22, 16, v18
    v_and_b32 v23, 0xffff0000, v18
    v_lshlrev_b32 v24, 16, v19
    v_and_b32 v25, 0xffff0000, v19
    v_pk_mul_f32 v[46:47], v[22:23], s[56:57]
    v_pk_mul_f32 v[48:49], v[24:25], s[56:57]
    v_exp_f32 v46, v46
    v_exp_f32 v47, v47
    v_exp_f32 v48, v48
    v_exp_f32 v49, v49
    s_nop 0
    v_pk_add_f32 v[46:47], v[46:47], s[54:55]
    v_pk_add_f32 v[48:49], v[48:49], s[54:55]
    v_rcp_f32 v46, v46
    v_rcp_f32 v47, v47
    v_rcp_f32 v48, v48
    v_rcp_f32 v49, v49
    s_nop 0
    v_pk_mul_f32 v[22:23], v[22:23], v[46:47]
    v_pk_mul_f32 v[24:25], v[24:25], v[48:49]
    v_cvt_pk_bf16_f32 v18, v22, v23
    v_cvt_pk_bf16_f32 v19, v24, v25
    v_lshlrev_b32 v22, 16, v18
    v_and_b32 v23, 0xffff0000, v18
    v_lshlrev_b32 v24, 16, v19
    v_and_b32 v25, 0xffff0000, v19
W_84:
    ds_read_b32 v18, v11 offset:17568
    s_waitcnt lgkmcnt(0)
    v_readfirstlane_b32 s94, v18
    s_cmp_ge_i32 s94, 1
    s_cbranch_scc1 D_85
    s_sub_u32 s81, s81, 1
    s_cmp_gt_i32 s81, 0
    s_cbranch_scc1 W_84
D_85:
    s_mov_b32 s4, -1
    s_mov_b32 s5, -1
    s_mov_b32 s6, -1
    s_mov_b32 s7, -1
P_86:
    s_wqm_b64 exec, s[4:5]
    s_cbranch_execz K_88
    buffer_load_dwordx4 v[30:33], v139, s[60:63], s42 offen offset:0 sc1
K_88:
    s_wqm_b64 exec, s[6:7]
    s_cbranch_execz K_89
    buffer_load_dwordx4 v[34:37], v139, s[60:63], s42 offen offset:1024 sc1
K_89:
    s_mov_b64 exec, -1
    s_sub_u32 s81, s81, 16
    s_waitcnt vmcnt(0)
    v_cmp_ne_u32 s[4:5], s76, v33
    v_cmp_ne_u32 s[6:7], s76, v37
    s_or_b64 s[100:101], s[4:5], s[6:7]
    s_cbranch_scc0 PD_87
    s_cmp_gt_i32 s81, 0
    s_cbranch_scc1 P_86
PD_87:
    v_perm_b32 v33, v31, v30, s25
    v_lshl_or_b32 v33, v32, 24, v33
    v_perm_b32 v37, v35, v34, s25
    v_lshl_or_b32 v37, v36, 24, v37
    v_pk_add_f32 v[30:31], v[30:31], v[34:35]
    v_pk_add_f32 v[32:33], v[32:33], v[36:37]
    v_mov_b32 v34, v30
    v_mov_b32 v35, v31
    v_mov_b32 v36, v32
    v_mov_b32 v37, v33
    v_permlane16_swap_b32 v30, v34
    v_permlane16_swap_b32 v31, v35
    v_permlane16_swap_b32 v32, v36
    v_permlane16_swap_b32 v33, v37
    v_add_f32 v30, v30, v34
    v_add_f32 v31, v31, v35
    v_add_f32 v32, v32, v36
    v_add_f32 v33, v33, v37
    v_mov_b32 v34, v30
    v_mov_b32 v35, v31
    v_mov_b32 v36, v32
    v_mov_b32 v37, v33
    v_permlane32_swap_b32 v30, v34
    v_permlane32_swap_b32 v31, v35
    v_permlane32_swap_b32 v32, v36
    v_permlane32_swap_b32 v33, v37
    v_add_f32 v30, v30, v34
    v_add_f32 v31, v31, v35
    v_add_f32 v32, v32, v36
    v_add_f32 v33, v33, v37
    v_add_f32_dpp v30, v30, v30 row_ror:8 row_mask:0xf bank_mask:0xf
    v_add_f32_dpp v31, v31, v31 row_ror:8 row_mask:0xf bank_mask:0xf
    v_add_f32_dpp v32, v32, v32 row_ror:8 row_mask:0xf bank_mask:0xf
    v_add_f32_dpp v33, v33, v33 row_ror:8 row_mask:0xf bank_mask:0xf
    v_cvt_pk_bf16_f32 v18, v30, v31
    v_cvt_pk_bf16_f32 v19, v32, v33
    v_lshlrev_b32 v30, 16, v18
    v_and_b32 v31, 0xffff0000, v18
    v_lshlrev_b32 v32, 16, v19
    v_and_b32 v33, 0xffff0000, v19
    v_pk_mul_f32 v[30:31], v[30:31], v[22:23]
    v_pk_mul_f32 v[32:33], v[32:33], v[24:25]
    v_cvt_pk_bf16_f32 v18, v30, v31
    v_cvt_pk_bf16_f32 v19, v32, v33
    v_lshlrev_b32 v30, 16, v18
    v_and_b32 v31, 0xffff0000, v18
    v_lshlrev_b32 v32, 16, v19
    v_and_b32 v33, 0xffff0000, v19
    v_pk_add_f32 v[30:31], v[30:31], v[26:27]
    v_pk_add_f32 v[32:33], v[32:33], v[28:29]
    s_mov_b64 exec, 0xff
    v_cvt_pk_bf16_f32 v30, v30, v31
    v_cvt_pk_bf16_f32 v31, v32, v33
    buffer_store_dwordx2 v[30:31], v140, s[64:67], s43 offen
    s_mov_b64 exec, -1
    s_cmp_lg_u32 s2, 0
    s_cbranch_scc1 L_fin_wave
    s_mov_b64 exec, 1
    s_movk_i32 s91, 4096
    buffer_store_dwordx2 v[8:9], v6, s[60:63], s91 offen sc1
    s_mov_b64 exec, -1
L_fin_wave:
    s_endpgm
.section .rodata,"a"
.p2align 6
.amdhsa_kernel recurrent_scan__sliding_block_cached__dense_activation_gelu__decode_kernel
  .amdhsa_next_free_vgpr 152
  .amdhsa_next_free_sgpr 102
  .amdhsa_accum_offset 152
  .amdhsa_group_segment_fixed_size 0
  .amdhsa_kernarg_size 104
  .amdhsa_user_sgpr_count 2
  .amdhsa_user_sgpr_kernarg_segment_ptr 1
  .amdhsa_system_sgpr_workgroup_id_x 1
.end_amdhsa_kernel
```
